```python
import torch

def _softmax(x, axis=-1):
    return torch.softmax(x, dim=axis)
def _gelu(x):
    return torch.nn.functional.gelu(x, approximate="tanh")
def _silu(x):
    return torch.nn.functional.silu(x)
def _sigmoid(x):
    return torch.sigmoid(x)
def _layernorm(x, axis=-1, eps=1e-5):
    m = x.mean(dim=axis, keepdim=True)
    v = x.var(dim=axis, keepdim=True, unbiased=False)
    return (x - m) / torch.sqrt(v + eps)
def _scatter_add(tgt, idx, src, axis=0):
    return tgt.clone().index_add_(axis, idx, src)
def _segment_sum(src, seg, n):
    out = torch.zeros((n,) + src.shape[1:], dtype=src.dtype)
    return out.index_add_(0, seg, src)
def _pad(x, pw):
    flat = tuple(v for pair in reversed(pw) for v in pair)
    return torch.nn.functional.pad(x, flat)

kernel_name = 'recurrent_scan__linear_kernel_hedgehog__dense_activation_silu__prompt'

def setup_inputs():

    _w = (lambda a: (lambda t: t.to(torch.bfloat16) if t.is_floating_point() else t)(torch.as_tensor(a)))
    def _A_setup():
        B, S, D, H = 1, 2048, 512, 32
        Dh = D // H
        return {
            "x": _w((lambda *s: torch.randn(*s, dtype=torch.bfloat16) * 0.05)(B, S, D)),
            "wqkv": _w((lambda *s: torch.randn(*s, dtype=torch.bfloat16) * 0.4)(D, 3 * D)),
            "w_phi": _w((lambda *s: torch.randn(*s, dtype=torch.bfloat16) * 0.4)(H, Dh, Dh) * (Dh ** -0.5)),
            "wo": _w((lambda *s: torch.randn(*s, dtype=torch.bfloat16) * 0.2)(D, D)),
        }
    _A_in = _A_setup()

    def _B_setup():
        B, S, D, F = 1, 2048, 512, 1376
        return {
            "x": _w((lambda *s: torch.randn(*s, dtype=torch.bfloat16) * 0.05)(B, S, D)),
            "w1": _w((lambda *s: torch.randn(*s, dtype=torch.bfloat16) * 0.4)(D, F) * (D ** -0.5)),
            "w2": _w((lambda *s: torch.randn(*s, dtype=torch.bfloat16) * 0.1)(F, D) * (F ** -0.5)),
        }
    _B_in = _B_setup()

    return {
        "A_x": _A_in["x"],
        "A_wqkv": _A_in["wqkv"],
        "A_w_phi": _A_in["w_phi"],
        "A_wo": _A_in["wo"],
        "B_x": _B_in["x"],
        "B_w1": _B_in["w1"],
        "B_w2": _B_in["w2"],
    }

def reference(A_x, A_wqkv, A_w_phi, A_wo, B_x, B_w1, B_w2):
    def _A_ref(x, wqkv, w_phi, wo):
        B, S, D = x.shape
        H = 32; Dh = D // H
        qkv = (lambda x, *d: x.permute(*d))((x @ wqkv).reshape(B, S, 3, H, Dh), 2, 0, 3, 1, 4)
        q, k, v = qkv[0], qkv[1], qkv[2]
        pq = torch.einsum("bhsd,hdf->bhsf", q, w_phi)
        pk = torch.einsum("bhsd,hdf->bhsf", k, w_phi)
        phi_q = torch.concatenate([_softmax(pq, axis=-1), _softmax(-pq, axis=-1)], axis=-1)
        phi_k = torch.concatenate([_softmax(pk, axis=-1), _softmax(-pk, axis=-1)], axis=-1)
        kv = torch.einsum("bhsf,bhsd->bhfd", phi_k, v)
        z  = torch.einsum("bhsf->bhf", phi_k)
        num = torch.einsum("bhqf,bhfd->bhqd", phi_q, kv)
        den = torch.einsum("bhqf,bhf->bhq", phi_q, z)[..., None] + 1e-6
        o = num / den
        return (lambda x, *d: x.permute(*d))(o, 0, 2, 1, 3).reshape(B, S, D) @ wo

    def _B_ref(x, w1, w2):
        h = torch.einsum("bsd,df->bsf", x, w1)
        h = _silu(h)
        out = torch.einsum("bsf,fd->bsd", h, w2)
        return out

    x = A_x
    xn = _layernorm(x, axis=-1)
    s = _A_ref(xn, A_wqkv, A_w_phi, A_wo)
    g = _silu(_B_ref(xn, B_w1, B_w2))
    return x + s * g
```

```asm
; @launch grid=(256,1,1) block=(256,1,1) lds=163840
.amdgcn_target "amdgcn-amd-amdhsa--gfx950"
.text
.globl recurrent_scan__linear_kernel_hedgehog__dense_activation_silu__prompt_kernel
.p2align 8
.type recurrent_scan__linear_kernel_hedgehog__dense_activation_silu__prompt_kernel,@function
recurrent_scan__linear_kernel_hedgehog__dense_activation_silu__prompt_kernel:
L_start:
  s_cmp_ge_u32 s2, 256
  s_cbranch_scc1 L_end
  s_load_dwordx16 s[72:87], s[0:1], 0
  s_load_dwordx4 s[88:91], s[0:1], 64
  s_getpc_b64 s[96:97]
L_pc:
  s_sub_u32 s96, s96, L_pc-L_start
  s_subb_u32 s97, s97, 0
  s_mov_b32 s98, L_codeend-L_start
  s_mov_b32 s99, 0x00020000
  s_lshr_b32 s53, s2, 3
  s_and_b32 s53, s53, 3
  s_lshl_b32 s53, s53, 13
  v_lshlrev_b32 v2, 7, v0
  v_cmp_gt_u32 vcc, 64, v0
  v_mov_b32_e64 v3, 1073741824
  s_nop 0
  v_cndmask_b32 v2, v3, v2, vcc
  buffer_load_dword v96, v2, s[96:99], s53 offen
  v_lshrrev_b32 v2, 6, v0
  v_and_b32 v1, 63, v0
  v_readfirstlane_b32 s36, v2
  s_and_b32 s53, s2, 7
  s_lshr_b32 s54, s2, 3
  s_and_b32 s40, s53, 1
  s_lshr_b32 s53, s53, 1
  s_lshl_b32 s53, s53, 2
  s_lshr_b32 s55, s54, 3
  s_add_u32 s37, s53, s55
  s_and_b32 s39, s54, 7
  s_lshl_b32 s53, s40, 3
  s_add_u32 s38, s53, s39
  s_lshr_b32 s41, s36, 1
  s_and_b32 s42, s36, 1
  s_and_b32 s43, s37, 1
  s_lshr_b32 s44, s37, 2
  s_lshl_b32 s44, s44, 1
  s_bfe_u32 s3, s37, 0x10001
  s_lshl_b32 s53, s37, 1
  s_add_u32 s45, s53, s40
  s_lshl_b32 s50, s36, 12
  s_mul_i32 s51, s36, 6144
  s_add_u32 s51, s51, 16384
  s_lshl_b32 s52, s36, 10
  s_mul_i32 s53, s39, 6
  s_mul_i32 s54, s39, 5
  s_add_u32 s54, s54, 3
  s_cmp_lt_u32 s39, 3
  s_cselect_b32 s61, s53, s54
  s_lshl_b32 s53, s39, 7
  s_lshl_b32 s54, s61, 6
  s_cmp_eq_u32 s40, 0
  s_mov_b32 s46, 3072
  s_cselect_b32 s46, s46, 2752
  s_mov_b32 s55, 1024
  s_cselect_b32 s55, s55, 128
  s_cselect_b32 s56, s53, s54
  s_lshl_b32 s62, s46, 6
  s_lshl_b32 s63, s46, 3
  v_lshrrev_b32 v2, 3, v1
  v_and_b32 v3, 7, v1
  v_lshrrev_b32 v4, 1, v2
  v_xor_b32 v3, v3, v4
  v_lshlrev_b32 v3, 4, v3
  v_lshl_or_b32 v3, v2, 10, v3
  s_lshl_b32 s53, s37, 7
  s_lshl_b32 s54, s36, 5
  s_add_u32 s53, s53, s54
  s_lshl_b32 s53, s53, 10
  v_add_u32 v24, s53, v3
  v_xor_b32 v3, 64, v24
  v_add_u32 v25, 0x2000, v3
  v_add_u32 v26, 0x4000, v24
  v_add_u32 v27, 0x6000, v3
  v_lshrrev_b32_e64 v2, 4, v1
  v_bfe_u32 v3, v1, 2, 2
  v_and_b32 v4, 3, v1
  v_lshlrev_b32 v4, 4, v4
  s_lshl_b32 s53, s36, 4
  v_add_u32 v3, s53, v3
  v_add_u32_e64 v4, s56, v4
  v_mad_u32_u24 v4, v3, s46, v4
  v_and_b32_e64 v5, 1, v2
  v_lshl_add_u32 v4, v5, 6, v4
  v_lshrrev_b32_e64 v2, 1, v2
  v_mad_u32_u24 v28, v2, s55, v4
  s_lshl_b32 s53, s55, 1
  s_lshl_b32 s54, s46, 2
  v_mov_b32 v5, s53
  v_mov_b32 v6, s54
  v_cmp_eq_u32 vcc, 0, v2
  s_nop 1
  v_cndmask_b32 v5, v6, v5, vcc
  v_add_u32 v29, v4, v5
  s_add_u32 s54, s54, s55
  v_add_u32 v30, s54, v28
  s_cmp_ge_u32 s38, 11
  s_cbranch_scc0 L_zt_1
  v_lshrrev_b32 v2, 4, v1
  v_mov_b32 v3, 1073741824
  v_cmp_eq_u32 vcc, 1, v2
  s_nop 1
  v_cndmask_b32 v29, v29, v3, vcc
  v_cmp_eq_u32 vcc, 3, v2
  s_nop 1
  v_cndmask_b32 v30, v30, v3, vcc
L_zt_1:
  v_lshlrev_b32_e64 v41, 4, v1
  s_lshl_b32 s57, s37, 7
  s_lshl_b32 s53, s38, 3
  s_add_u32 s57, s57, s53
  s_lshl_b32 s53, s36, 1
  s_add_u32 s57, s57, s53
  s_lshl_b32 s58, s57, 10
  s_add_u32 s53, s44, 0
  s_and_b32 s53, s53, 7
  s_lshl_b32 s47, s53, 7
  s_mul_i32 s48, s53, s62
  s_add_u32 s49, s48, s63
  s_waitcnt lgkmcnt(0)
  s_mov_b32 s4, s72
  s_mov_b32 s5, s73
  s_mov_b32 s6, 2097152
  s_mov_b32 s7, 0x00020000
  s_cmp_eq_u32 s40, 0
  s_cselect_b32 s8, s74, s82
  s_cselect_b32 s9, s75, s83
  s_mov_b32 s10, 1572864
  s_cselect_b32 s10, s10, 1409024
  s_mov_b32 s11, 0x00020000
  s_mov_b32 s12, s90
  s_mov_b32 s13, s91
  s_mov_b32 s14, 16777216
  s_mov_b32 s15, 0x00020000
  s_cmp_eq_u32 s2, 0
  s_cbranch_scc0 L_nz_2
  v_mov_b32 v8, 0
  v_mov_b32 v9, 0
  v_mov_b32 v10, 0
  v_mov_b32 v11, 0
  v_lshlrev_b32_e64 v2, 4, v0
  s_mov_b32 s53, 0
  buffer_store_dwordx4 v[8:11], v2, s[12:15], s53 offen sc1
  s_mov_b32 s53, 4096
  buffer_store_dwordx4 v[8:11], v2, s[12:15], s53 offen sc1
  s_mov_b32 s53, 8192
  buffer_store_dwordx4 v[8:11], v2, s[12:15], s53 offen sc1
  s_mov_b32 s53, 12288
  buffer_store_dwordx4 v[8:11], v2, s[12:15], s53 offen sc1
  s_mov_b32 s53, 16384
  buffer_store_dwordx4 v[8:11], v2, s[12:15], s53 offen sc1
L_nz_2:
  buffer_load_dwordx4 v[240:243], v41, s[4:7], s58 offen
  buffer_load_dwordx4 v[244:247], v41, s[4:7], s58 offen offset:1024
  s_add_u32 m0, s50, 0
  s_nop 0
  buffer_load_dwordx4 v24, s[4:7], s47 offen lds
  s_add_u32 m0, s50, 1024
  s_nop 0
  buffer_load_dwordx4 v25, s[4:7], s47 offen lds
  s_add_u32 m0, s50, 2048
  s_nop 0
  buffer_load_dwordx4 v26, s[4:7], s47 offen lds
  s_add_u32 m0, s50, 3072
  s_nop 0
  buffer_load_dwordx4 v27, s[4:7], s47 offen lds
  s_add_u32 m0, s51, 0
  s_nop 0
  buffer_load_dwordx4 v28, s[8:11], s48 offen lds
  s_add_u32 m0, s51, 1024
  s_nop 0
  buffer_load_dwordx4 v29, s[8:11], s48 offen lds
  s_add_u32 m0, s51, 2048
  s_nop 0
  buffer_load_dwordx4 v30, s[8:11], s48 offen lds
  s_add_u32 m0, s51, 3072
  s_nop 0
  buffer_load_dwordx4 v28, s[8:11], s49 offen lds
  s_add_u32 m0, s51, 4096
  s_nop 0
  buffer_load_dwordx4 v29, s[8:11], s49 offen lds
  s_add_u32 m0, s51, 5120
  s_nop 0
  buffer_load_dwordx4 v30, s[8:11], s49 offen lds
  s_and_b32 s53, s38, 3
  s_cmp_lg_u32 s53, 3
  s_cselect_b32 s1, 1, 0
  s_cmp_lt_u32 s38, 8
  s_cselect_b32 s1, s1, 0
  s_cmp_eq_u32 s36, 3
  s_cselect_b32 s1, s1, 0
  s_lshr_b32 s53, s39, 2
  s_sub_u32 s53, s39, s53
  s_lshl_b32 s53, s53, 2
  s_and_b32 s54, s37, 3
  s_add_u32 s53, s53, s54
  s_lshl_b32 s53, s53, 3
  v_add_u32 v2, s53, v1
  v_mul_u32_u24 v3, 0x5556, v2
  v_lshrrev_b32 v3, 16, v3
  v_mul_u32_u24 v4, 3, v3
  v_sub_u32 v4, v2, v4
  v_mul_u32_u24 v3, s46, v3
  v_lshrrev_b32 v3, 7, v3
  v_add_u32 v3, 4, v3
  v_and_b32 v3, 0xfffffff8, v3
  v_add_u32 v3, 3, v3
  v_lshl_add_u32 v3, v4, 3, v3
  v_lshlrev_b32 v93, 7, v3
  s_cmp_eq_u32 s1, 1
  s_cbranch_scc0 L_sp3_3
  s_add_u32 s54, s44, 1
  s_and_b32 s54, s54, 7
  s_mul_i32 s54, s54, s62
  s_mov_b32 exec_lo, 0xff
  s_mov_b32 exec_hi, 0
  buffer_load_dword v94, v93, s[8:11], s54 offen
  s_mov_b64 exec, -1
L_sp3_3:
  s_cmp_eq_u32 s1, 1
  s_cbranch_scc0 L_sp3_4
  s_add_u32 s54, s44, 2
  s_and_b32 s54, s54, 7
  s_mul_i32 s54, s54, s62
  s_mov_b32 exec_lo, 0xff
  s_mov_b32 exec_hi, 0
  buffer_load_dword v94, v93, s[8:11], s54 offen
  s_mov_b64 exec, -1
L_sp3_4:
  s_cmp_eq_u32 s36, 2
  s_cbranch_scc0 L_spx_5
  s_lshl_b32 s53, s37, 7
  s_lshl_b32 s54, s39, 4
  s_add_u32 s53, s53, s54
  s_lshl_b32 s53, s53, 10
  s_add_u32 s53, s53, 384
  v_lshlrev_b32 v2, 10, v1
  s_mov_b32 exec_lo, 0xffff
  s_mov_b32 exec_hi, 0
  buffer_load_dword v94, v2, s[4:7], s53 offen
  s_mov_b64 exec, -1
L_spx_5:
  s_add_u32 s53, s44, 1
  s_and_b32 s53, s53, 7
  s_lshl_b32 s47, s53, 7
  s_mul_i32 s48, s53, s62
  s_add_u32 s49, s48, s63
  s_add_u32 m0, s50, 40960
  s_nop 0
  buffer_load_dwordx4 v24, s[4:7], s47 offen lds
  s_add_u32 m0, s50, 41984
  s_nop 0
  buffer_load_dwordx4 v25, s[4:7], s47 offen lds
  s_add_u32 m0, s50, 43008
  s_nop 0
  buffer_load_dwordx4 v26, s[4:7], s47 offen lds
  s_add_u32 m0, s50, 44032
  s_nop 0
  buffer_load_dwordx4 v27, s[4:7], s47 offen lds
  s_add_u32 m0, s51, 40960
  s_nop 0
  buffer_load_dwordx4 v28, s[8:11], s48 offen lds
  s_mov_b32 s94, s58
  s_mov_b32 s95, s57
  s_mov_b32 s16, s84
  s_mov_b32 s17, s85
  s_mov_b32 s18, 1409024
  s_mov_b32 s19, 0x00020000
  s_mov_b32 s20, s78
  s_mov_b32 s21, s79
  s_mov_b32 s22, 524288
  s_mov_b32 s23, 0x00020000
  s_mov_b32 s24, s86
  s_mov_b32 s25, s87
  s_mov_b32 s26, 2097152
  s_mov_b32 s27, 0x00020000
  s_mov_b32 s28, s76
  s_mov_b32 s29, s77
  s_mov_b32 s30, 16384
  s_mov_b32 s31, 0x00020000
  s_mov_b32 s32, s88
  s_mov_b32 s33, s89
  s_mov_b32 s34, 256
  s_mov_b32 s35, 0x00020000
  s_mov_b32 s64, 0x3fb8aa3b
  s_mov_b32 s65, 0x3fb8aa3b
  s_mov_b32 s68, -1
  s_mov_b32 s69, 0
  s_lshl_b32 s93, s39, 1
  s_add_u32 s93, s93, s42
  s_lshl_b32 s92, s45, 1
  s_add_u32 s92, s92, s41
  s_lshl_b32 s53, s36, 12
  s_add_u32 s53, s53, 131072
  s_mov_b32 m0, s53
  s_lshl_b32 s54, s93, 10
  buffer_load_dwordx4 v41, s[28:31], s54 offen lds
  v_mov_b32 v8, 0
  v_mov_b32 v9, 0
  v_lshrrev_b32 v2, 1, v41
  v_add_u32_e64 v2, s53, v2
  ds_write_b64 v2, v[8:9] offset:1024
  v_lshrrev_b32 v3, 5, v1
  v_and_b32 v4, 1, v1
  v_bfe_u32 v5, v1, 2, 2
  v_lshlrev_b32_e64 v5, 5, v5
  v_lshl_or_b32 v5, v3, 9, v5
  v_bfe_u32 v6, v1, 4, 1
  v_lshl_or_b32 v5, v6, 4, v5
  v_bfe_u32 v6, v1, 1, 1
  v_lshl_or_b32 v5, v6, 3, v5
  v_mov_b32 v6, 1024
  v_cmp_eq_u32 vcc, v3, v4
  s_nop 1
  v_cndmask_b32 v5, v6, v5, vcc
  v_add_u32 v92, s53, v5
  s_or_b32 s53, s40, s36
  s_cmp_eq_u32 s53, 0
  s_cbranch_scc0 L_nkz_6
  v_mov_b32 v8, 0
  v_mov_b32 v9, 0
  v_mov_b32 v10, 0
  v_mov_b32_e64 v11, 0
  s_mul_i32 s53, s39, 8704
  s_mul_i32 s54, s37, 544
  s_add_u32 s53, s53, s54
  s_add_u32 s53, s53, 32768
  v_cmp_gt_u32 vcc, 34, v1
  s_and_saveexec_b64 s[66:67], vcc
  buffer_store_dwordx4 v[8:11], v41, s[12:15], s53 offen sc1
  s_mov_b64 exec, s[66:67]
L_nkz_6:
  s_cmp_eq_u32 s2, 0
  s_cbranch_scc0 L_nb_7
  s_waitcnt vmcnt(18)
  s_barrier
  s_cmp_eq_u32 s36, 0
  s_cbranch_scc0 L_nb2_8
  v_mov_b32 v14, 0
  v_mov_b32 v15, 1
  s_mov_b64 s[66:67], exec
  s_mov_b64 exec, 1
  buffer_store_dword v15, v14, s[32:35], 0 offen sc1
  s_mov_b64 exec, s[66:67]
L_nb2_8:
L_nb_7:
  v_and_b32 v2, 31, v1
  v_lshrrev_b32_e64 v3, 5, v1
  v_bfe_u32 v4, v2, 1, 3
  v_xor_b32 v4, v4, v3
  s_lshl_b32 s53, s43, 2
  v_xor_b32 v4, s53, v4
  v_lshlrev_b32 v4, 4, v4
  s_lshl_b32 s53, s41, 6
  v_add_u32 v5, s53, v2
  v_lshl_or_b32 v32, v5, 7, v4
  v_xor_b32 v33, 32, v32
  v_xor_b32 v34, 64, v32
  v_xor_b32 v35, 96, v32
  v_bfe_u32 v4, v1, 2, 2
  v_lshlrev_b32 v4, 6, v4
  v_and_b32 v5, 1, v1
  v_lshl_or_b32 v4, v5, 5, v4
  v_bfe_u32 v5, v1, 4, 1
  v_lshl_or_b32 v4, v5, 4, v4
  v_bfe_u32 v5, v1, 1, 1
  v_lshl_or_b32 v4, v5, 3, v4
  v_mul_u32_u24 v5, 3072, v3
  v_add_u32 v5, v5, v4
  s_lshl_b32 s53, s42, 8
  s_add_u32 s53, s53, 16384
  s_mul_i32 s54, s43, 12288
  s_add_u32 s55, s53, s54
  v_add_u32 v36, s55, v5
  s_sub_u32 s54, 12288, s54
  s_add_u32 s55, s53, s54
  v_add_u32 v37, s55, v5
  v_mov_b32 v88, 0x3f803f80
  v_mov_b32 v89, 0x3f803f80
  v_mov_b32 v90, 0x3f803f80
  v_mov_b32 v91, 0x3f803f80
  v_add_u32 v2, 159744, v41
  ds_write_b128 v2, v[88:91]
  s_waitcnt vmcnt(16)
  s_nop 0
  v_dot2_f32_bf16 v8, v240, v88, 0
  v_dot2_f32_bf16 v9, v240, v240, 0
  v_dot2_f32_bf16 v10, v244, v88, 0
  v_dot2_f32_bf16 v11, v244, v244, 0
  v_dot2_f32_bf16 v8, v241, v88, v8
  v_dot2_f32_bf16 v9, v241, v241, v9
  v_dot2_f32_bf16 v10, v245, v88, v10
  v_dot2_f32_bf16 v11, v245, v245, v11
  v_dot2_f32_bf16 v8, v242, v88, v8
  v_dot2_f32_bf16 v9, v242, v242, v9
  v_dot2_f32_bf16 v10, v246, v88, v10
  v_dot2_f32_bf16 v11, v246, v246, v11
  v_dot2_f32_bf16 v8, v243, v88, v8
  v_dot2_f32_bf16 v9, v243, v243, v9
  v_dot2_f32_bf16 v10, v247, v88, v10
  v_dot2_f32_bf16 v11, v247, v247, v11
  v_add_f32_dpp v8, v8, v8 row_shr:1 row_mask:0xf bank_mask:0xf
  v_add_f32_dpp v9, v9, v9 row_shr:1 row_mask:0xf bank_mask:0xf
  v_add_f32_dpp v10, v10, v10 row_shr:1 row_mask:0xf bank_mask:0xf
  v_add_f32_dpp v11, v11, v11 row_shr:1 row_mask:0xf bank_mask:0xf
  v_add_f32_dpp v8, v8, v8 row_shr:2 row_mask:0xf bank_mask:0xf
  v_add_f32_dpp v9, v9, v9 row_shr:2 row_mask:0xf bank_mask:0xf
  v_add_f32_dpp v10, v10, v10 row_shr:2 row_mask:0xf bank_mask:0xf
  v_add_f32_dpp v11, v11, v11 row_shr:2 row_mask:0xf bank_mask:0xf
  v_add_f32_dpp v8, v8, v8 row_shr:4 row_mask:0xf bank_mask:0xf
  v_add_f32_dpp v9, v9, v9 row_shr:4 row_mask:0xf bank_mask:0xf
  v_add_f32_dpp v10, v10, v10 row_shr:4 row_mask:0xf bank_mask:0xf
  v_add_f32_dpp v11, v11, v11 row_shr:4 row_mask:0xf bank_mask:0xf
  v_add_f32_dpp v8, v8, v8 row_shr:8 row_mask:0xf bank_mask:0xf
  v_add_f32_dpp v9, v9, v9 row_shr:8 row_mask:0xf bank_mask:0xf
  v_add_f32_dpp v10, v10, v10 row_shr:8 row_mask:0xf bank_mask:0xf
  v_add_f32_dpp v11, v11, v11 row_shr:8 row_mask:0xf bank_mask:0xf
  v_add_f32_dpp v8, v8, v8 row_bcast:15 row_mask:0xa bank_mask:0xf
  v_add_f32_dpp v9, v9, v9 row_bcast:15 row_mask:0xa bank_mask:0xf
  v_add_f32_dpp v10, v10, v10 row_bcast:15 row_mask:0xa bank_mask:0xf
  v_add_f32_dpp v11, v11, v11 row_bcast:15 row_mask:0xa bank_mask:0xf
  v_add_f32_dpp v8, v8, v8 row_bcast:31 row_mask:0xc bank_mask:0xf
  v_add_f32_dpp v9, v9, v9 row_bcast:31 row_mask:0xc bank_mask:0xf
  v_add_f32_dpp v10, v10, v10 row_bcast:31 row_mask:0xc bank_mask:0xf
  v_add_f32_dpp v11, v11, v11 row_bcast:31 row_mask:0xc bank_mask:0xf
  v_readlane_b32 s100, v8, 63
  v_readlane_b32 s101, v9, 63
  v_readlane_b32 s70, v10, 63
  v_readlane_b32 s71, v11, 63
  v_mov_b32 v8, s100
  v_mov_b32_e64 v9, s101
  s_nop 0
  v_writelane_b32 v8, s70, 1
  v_writelane_b32 v9, s71, 1
  v_mul_f32 v8, 0x3b000000, v8
  v_mul_f32 v9, 0x3b000000, v9
  v_fma_f32 v9, -v8, v8, v9
  v_max_f32_e64 v9, 0, v9
  v_add_f32 v9, 0x3727c5ac, v9
  v_rsq_f32 v9, v9
  s_lshl_b32 s53, s95, 2
  v_lshl_add_u32 v10, v1, 2, s53
  s_mov_b32 s53, 131072
  s_mov_b32 s54, 139264
  s_mov_b64 exec, 3
  buffer_store_dword v8, v10, s[12:15], s53 offen sc1
  buffer_store_dword v9, v10, s[12:15], s54 offen sc1
  s_mov_b64 exec, -1
  s_add_u32 m0, s51, 41984
  s_nop 0
  buffer_load_dwordx4 v29, s[8:11], s48 offen lds
  s_add_u32 m0, s51, 43008
  s_nop 0
  buffer_load_dwordx4 v30, s[8:11], s48 offen lds
  s_add_u32 m0, s51, 44032
  s_nop 0
  buffer_load_dwordx4 v28, s[8:11], s49 offen lds
  s_add_u32 m0, s51, 45056
  s_nop 0
  buffer_load_dwordx4 v29, s[8:11], s49 offen lds
  s_add_u32 m0, s51, 46080
  s_nop 0
  buffer_load_dwordx4 v30, s[8:11], s49 offen lds
  s_waitcnt vmcnt(13) lgkmcnt(0)
  s_barrier
  s_nop 0
  ds_read_b128 v[48:51], v32 offset:0
  ds_read_b64_tr_b16 v[64:65], v36 offset:0
  ds_read_b64_tr_b16 v[66:67], v36 offset:1536
  ds_read_b128 v[52:55], v32 offset:4096
  v_add_u32 v32, 0xa000, v32
  ds_read_b64_tr_b16 v[68:69], v36 offset:512
  ds_read_b64_tr_b16 v[70:71], v36 offset:2048
  ds_read_b64_tr_b16 v[72:73], v36 offset:1024
  ds_read_b64_tr_b16 v[74:75], v36 offset:2560
  s_waitcnt lgkmcnt(4)
  v_mfma_f32_32x32x16_bf16 v[96:111], v[64:67], v[48:51], 0
  ds_read_b128 v[56:59], v33 offset:0
  ds_read_b64_tr_b16 v[76:77], v36 offset:6144
  s_add_u32 s53, s44, 2
  s_and_b32 s53, s53, 7
  s_lshl_b32 s47, s53, 7
  s_mul_i32 s48, s53, s62
  s_add_u32 s49, s48, s63
  s_add_u32 m0, s50, 81920
  v_mfma_f32_32x32x16_bf16 v[112:127], v[64:67], v[52:55], 0
  ds_read_b64_tr_b16 v[78:79], v36 offset:7680
  ds_read_b128 v[60:63], v33 offset:4096
  v_add_u32 v33, 0xa000, v33
  buffer_load_dwordx4 v24, s[4:7], s47 offen lds
  s_waitcnt lgkmcnt(6)
  s_add_u32 m0, s50, 82944
  v_mfma_f32_32x32x16_bf16 v[144:159], v[68:71], v[52:55], 0
  ds_read_b64_tr_b16 v[80:81], v36 offset:6656
  ds_read_b64_tr_b16 v[82:83], v36 offset:8192
  buffer_load_dwordx4 v25, s[4:7], s47 offen lds
  s_add_u32 m0, s50, 83968
  v_mfma_f32_32x32x16_bf16 v[128:143], v[68:71], v[48:51], 0
  ds_read_b64_tr_b16 v[84:85], v36 offset:7168
  ds_read_b64_tr_b16 v[86:87], v36 offset:8704
  v_add_u32 v36, 0xa000, v36
  buffer_load_dwordx4 v26, s[4:7], s47 offen lds
  s_waitcnt lgkmcnt(8)
  s_add_u32 m0, s50, 84992
  v_mfma_f32_32x32x16_bf16 v[160:175], v[72:75], v[48:51], 0
  buffer_load_dwordx4 v27, s[4:7], s47 offen lds
  s_cmp_eq_u32 s1, 1
  s_cbranch_scc0 L_sp3_9
  s_add_u32 s54, s44, 3
  s_and_b32 s54, s54, 7
  s_mul_i32 s54, s54, s62
  s_mov_b32 exec_lo, 0xff
  s_mov_b32 exec_hi, 0
  buffer_load_dword v94, v93, s[8:11], s54 offen
  s_mov_b64 exec, -1
L_sp3_9:
  s_add_u32 m0, s51, 81920
  v_mfma_f32_32x32x16_bf16 v[176:191], v[72:75], v[52:55], 0
  buffer_load_dwordx4 v28, s[8:11], s48 offen lds
  s_lshl_b32 s53, s41, 1
  s_xor_b32 s53, s53, s3
  s_cmp_eq_u32 s53, 0
  s_cbranch_scc0 L_cs_10
  v_mfma_f32_32x32x16_bf16 v[192:207], v[88:91], v[64:67], 0
  v_mfma_f32_32x32x16_bf16 v[208:223], v[88:91], v[68:71], 0
  v_mfma_f32_32x32x16_bf16 v[224:239], v[88:91], v[72:75], 0
L_cs_10:
  s_waitcnt lgkmcnt(4)
  v_mfma_f32_32x32x16_bf16 v[96:111], v[76:79], v[56:59], v[96:111]
  ds_read_b128 v[48:51], v34 offset:0
  ds_read_b64_tr_b16 v[64:65], v37 offset:0
  s_add_u32 m0, s51, 82944
  v_mfma_f32_32x32x16_bf16 v[112:127], v[76:79], v[60:63], v[112:127]
  ds_read_b64_tr_b16 v[66:67], v37 offset:1536
  ds_read_b128 v[52:55], v34 offset:4096
  v_add_u32 v34, 0xa000, v34
  buffer_load_dwordx4 v29, s[8:11], s48 offen lds
  s_waitcnt lgkmcnt(6)
  s_add_u32 m0, s51, 83968
  v_mfma_f32_32x32x16_bf16 v[144:159], v[80:83], v[60:63], v[144:159]
  ds_read_b64_tr_b16 v[68:69], v37 offset:512
  ds_read_b64_tr_b16 v[70:71], v37 offset:2048
  buffer_load_dwordx4 v30, s[8:11], s48 offen lds
  s_add_u32 m0, s51, 84992
  v_mfma_f32_32x32x16_bf16 v[128:143], v[80:83], v[56:59], v[128:143]
  ds_read_b64_tr_b16 v[72:73], v37 offset:1024
  ds_read_b64_tr_b16 v[74:75], v37 offset:2560
  buffer_load_dwordx4 v28, s[8:11], s49 offen lds
  s_waitcnt lgkmcnt(8)
  s_add_u32 m0, s51, 86016
  v_mfma_f32_32x32x16_bf16 v[160:175], v[84:87], v[56:59], v[160:175]
  buffer_load_dwordx4 v29, s[8:11], s49 offen lds
  s_add_u32 m0, s51, 87040
  v_mfma_f32_32x32x16_bf16 v[176:191], v[84:87], v[60:63], v[176:191]
  buffer_load_dwordx4 v30, s[8:11], s49 offen lds
  s_lshl_b32 s53, s41, 1
  s_xor_b32 s53, s53, s3
  s_cmp_eq_u32 s53, 0
  s_cbranch_scc0 L_cs_11
  v_mfma_f32_32x32x16_bf16 v[192:207], v[88:91], v[76:79], v[192:207]
  v_mfma_f32_32x32x16_bf16 v[208:223], v[88:91], v[80:83], v[208:223]
  v_mfma_f32_32x32x16_bf16 v[224:239], v[88:91], v[84:87], v[224:239]
L_cs_11:
  s_waitcnt lgkmcnt(4)
  v_mfma_f32_32x32x16_bf16 v[96:111], v[64:67], v[48:51], v[96:111]
  ds_read_b128 v[56:59], v35 offset:0
  ds_read_b64_tr_b16 v[76:77], v37 offset:6144
  v_mfma_f32_32x32x16_bf16 v[112:127], v[64:67], v[52:55], v[112:127]
  ds_read_b64_tr_b16 v[78:79], v37 offset:7680
  ds_read_b128 v[60:63], v35 offset:4096
  v_add_u32 v35, 0xa000, v35
  s_waitcnt lgkmcnt(6)
  v_mfma_f32_32x32x16_bf16 v[144:159], v[68:71], v[52:55], v[144:159]
  ds_read_b64_tr_b16 v[80:81], v37 offset:6656
  ds_read_b64_tr_b16 v[82:83], v37 offset:8192
  v_mfma_f32_32x32x16_bf16 v[128:143], v[68:71], v[48:51], v[128:143]
  ds_read_b64_tr_b16 v[84:85], v37 offset:7168
  ds_read_b64_tr_b16 v[86:87], v37 offset:8704
  v_add_u32 v37, 0xa000, v37
  s_waitcnt lgkmcnt(8)
  v_mfma_f32_32x32x16_bf16 v[160:175], v[72:75], v[48:51], v[160:175]
  v_mfma_f32_32x32x16_bf16 v[176:191], v[72:75], v[52:55], v[176:191]
  s_waitcnt lgkmcnt(0)
  v_mfma_f32_32x32x16_bf16 v[96:111], v[76:79], v[56:59], v[96:111]
  s_waitcnt vmcnt(10)
  s_barrier
  v_mov_b32_e64 v12, 0
  buffer_load_dword v3, v12, s[32:35], 0 offen sc1
  s_add_u32 s53, s44, 3
  s_and_b32 s53, s53, 7
  s_lshl_b32 s47, s53, 7
  s_mul_i32 s48, s53, s62
  s_add_u32 s49, s48, s63
  ds_read_b128 v[48:51], v32 offset:0
  ds_read_b64_tr_b16 v[64:65], v36 offset:0
  v_mfma_f32_32x32x16_bf16 v[112:127], v[76:79], v[60:63], v[112:127]
  ds_read_b64_tr_b16 v[66:67], v36 offset:1536
  ds_read_b128 v[52:55], v32 offset:4096
  v_add_u32 v32, 0xa000, v32
  v_mfma_f32_32x32x16_bf16 v[144:159], v[80:83], v[60:63], v[144:159]
  ds_read_b64_tr_b16 v[68:69], v36 offset:512
  ds_read_b64_tr_b16 v[70:71], v36 offset:2048
  v_mfma_f32_32x32x16_bf16 v[128:143], v[80:83], v[56:59], v[128:143]
  ds_read_b64_tr_b16 v[72:73], v36 offset:1024
  ds_read_b64_tr_b16 v[74:75], v36 offset:2560
  s_add_u32 m0, s50, 0
  v_mfma_f32_32x32x16_bf16 v[160:175], v[84:87], v[56:59], v[160:175]
  buffer_load_dwordx4 v24, s[4:7], s47 offen lds
  s_add_u32 m0, s50, 1024
  v_mfma_f32_32x32x16_bf16 v[176:191], v[84:87], v[60:63], v[176:191]
  buffer_load_dwordx4 v25, s[4:7], s47 offen lds
  s_waitcnt lgkmcnt(4)
  v_mfma_f32_32x32x16_bf16 v[96:111], v[64:67], v[48:51], v[96:111]
  ds_read_b128 v[56:59], v33 offset:0
  ds_read_b64_tr_b16 v[76:77], v36 offset:6144
  v_mfma_f32_32x32x16_bf16 v[112:127], v[64:67], v[52:55], v[112:127]
  ds_read_b64_tr_b16 v[78:79], v36 offset:7680
  ds_read_b128 v[60:63], v33 offset:4096
  v_add_u32 v33, 0xa000, v33
  s_waitcnt lgkmcnt(6)
  v_mfma_f32_32x32x16_bf16 v[144:159], v[68:71], v[52:55], v[144:159]
  ds_read_b64_tr_b16 v[80:81], v36 offset:6656
  ds_read_b64_tr_b16 v[82:83], v36 offset:8192
  s_add_u32 m0, s50, 2048
  v_mfma_f32_32x32x16_bf16 v[128:143], v[68:71], v[48:51], v[128:143]
  ds_read_b64_tr_b16 v[84:85], v36 offset:7168
  ds_read_b64_tr_b16 v[86:87], v36 offset:8704
  v_add_u32 v36, 0xa000, v36
  buffer_load_dwordx4 v26, s[4:7], s47 offen lds
  s_waitcnt lgkmcnt(8)
  s_add_u32 m0, s50, 3072
  v_mfma_f32_32x32x16_bf16 v[160:175], v[72:75], v[48:51], v[160:175]
  buffer_load_dwordx4 v27, s[4:7], s47 offen lds
  s_cmp_eq_u32 s1, 1
  s_cbranch_scc0 L_sp3_12
  s_add_u32 s54, s44, 4
  s_and_b32 s54, s54, 7
  s_mul_i32 s54, s54, s62
  s_mov_b32 exec_lo, 0xff
  s_mov_b32 exec_hi, 0
  buffer_load_dword v94, v93, s[8:11], s54 offen
  s_mov_b64 exec, -1
L_sp3_12:
  s_add_u32 m0, s51, 0
  v_mfma_f32_32x32x16_bf16 v[176:191], v[72:75], v[52:55], v[176:191]
  buffer_load_dwordx4 v28, s[8:11], s48 offen lds
  s_lshl_b32 s53, s41, 1
  s_xor_b32 s53, s53, s3
  s_cmp_eq_u32 s53, 1
  s_cbranch_scc0 L_cs_13
  v_mfma_f32_32x32x16_bf16 v[192:207], v[88:91], v[64:67], 0
  v_mfma_f32_32x32x16_bf16 v[208:223], v[88:91], v[68:71], 0
  v_mfma_f32_32x32x16_bf16 v[224:239], v[88:91], v[72:75], 0
L_cs_13:
  s_waitcnt lgkmcnt(4)
  v_mfma_f32_32x32x16_bf16 v[96:111], v[76:79], v[56:59], v[96:111]
  ds_read_b128 v[48:51], v34 offset:0
  ds_read_b64_tr_b16 v[64:65], v37 offset:0
  s_lshr_b32 s53, s2, 3
  s_lshl_b32 s53, s53, 2
  s_add_u32 s53, s53, s36
  s_lshl_b32 s53, s53, 10
  v_bfe_u32 v2, v1, 3, 2
  v_lshlrev_b32 v2, 17, v2
  v_and_b32 v4, 7, v1
  v_lshl_or_b32 v2, v4, 7, v2
  s_mov_b32 exec_lo, 0xffff
  s_mov_b32 exec_hi, 0
  buffer_load_dword v252, v2, s[16:19], s53 offen
  s_mov_b64 exec, -1
  v_mfma_f32_32x32x16_bf16 v[112:127], v[76:79], v[60:63], v[112:127]
  ds_read_b64_tr_b16 v[66:67], v37 offset:1536
  ds_read_b128 v[52:55], v34 offset:4096
  v_add_u32 v34, 0xa000, v34
  s_waitcnt lgkmcnt(6)
  v_mfma_f32_32x32x16_bf16 v[144:159], v[80:83], v[60:63], v[144:159]
  ds_read_b64_tr_b16 v[68:69], v37 offset:512
  ds_read_b64_tr_b16 v[70:71], v37 offset:2048
  s_add_u32 m0, s51, 1024
  v_mfma_f32_32x32x16_bf16 v[128:143], v[80:83], v[56:59], v[128:143]
  ds_read_b64_tr_b16 v[72:73], v37 offset:1024
  ds_read_b64_tr_b16 v[74:75], v37 offset:2560
  buffer_load_dwordx4 v29, s[8:11], s48 offen lds
  s_waitcnt lgkmcnt(8)
  s_add_u32 m0, s51, 2048
  v_mfma_f32_32x32x16_bf16 v[160:175], v[84:87], v[56:59], v[160:175]
  buffer_load_dwordx4 v30, s[8:11], s48 offen lds
  s_add_u32 m0, s51, 3072
  v_mfma_f32_32x32x16_bf16 v[176:191], v[84:87], v[60:63], v[176:191]
  buffer_load_dwordx4 v28, s[8:11], s49 offen lds
  s_lshl_b32 s53, s41, 1
  s_xor_b32 s53, s53, s3
  s_cmp_eq_u32 s53, 1
  s_cbranch_scc0 L_cs_14
  v_mfma_f32_32x32x16_bf16 v[192:207], v[88:91], v[76:79], v[192:207]
  v_mfma_f32_32x32x16_bf16 v[208:223], v[88:91], v[80:83], v[208:223]
  v_mfma_f32_32x32x16_bf16 v[224:239], v[88:91], v[84:87], v[224:239]
L_cs_14:
  s_waitcnt lgkmcnt(4)
  v_mfma_f32_32x32x16_bf16 v[96:111], v[64:67], v[48:51], v[96:111]
  ds_read_b128 v[56:59], v35 offset:0
  ds_read_b64_tr_b16 v[76:77], v37 offset:6144
  v_mfma_f32_32x32x16_bf16 v[112:127], v[64:67], v[52:55], v[112:127]
  ds_read_b64_tr_b16 v[78:79], v37 offset:7680
  ds_read_b128 v[60:63], v35 offset:4096
  v_add_u32 v35, 0xa000, v35
  s_waitcnt lgkmcnt(6)
  v_mfma_f32_32x32x16_bf16 v[144:159], v[68:71], v[52:55], v[144:159]
  ds_read_b64_tr_b16 v[80:81], v37 offset:6656
  ds_read_b64_tr_b16 v[82:83], v37 offset:8192
  v_mfma_f32_32x32x16_bf16 v[128:143], v[68:71], v[48:51], v[128:143]
  ds_read_b64_tr_b16 v[84:85], v37 offset:7168
  ds_read_b64_tr_b16 v[86:87], v37 offset:8704
  v_add_u32 v37, 0xa000, v37
  s_waitcnt lgkmcnt(8)
  s_add_u32 m0, s51, 4096
  v_mfma_f32_32x32x16_bf16 v[160:175], v[72:75], v[48:51], v[160:175]
  buffer_load_dwordx4 v29, s[8:11], s49 offen lds
  s_add_u32 m0, s51, 5120
  v_mfma_f32_32x32x16_bf16 v[176:191], v[72:75], v[52:55], v[176:191]
  buffer_load_dwordx4 v30, s[8:11], s49 offen lds
  s_cmp_eq_u32 s41, 0
  s_cbranch_scc0 L_css_15
  s_mul_i32 s53, s38, 6
  s_add_u32 s53, s53, s42
  s_lshl_b32 s53, s53, 11
  s_bfe_u32 s54, s37, 0x10002
  s_lshl_b32 s54, s54, 10
  s_add_u32 s53, s53, s54
  s_lshr_b32 s54, s37, 3
  s_lshl_b32 s54, s54, 9
  s_add_u32 s53, s53, s54
  s_and_b32 s54, s37, 3
  s_lshl_b32 s54, s54, 2
  s_add_u32 s53, s53, s54
  s_add_u32 s53, s53, 147456
  v_lshlrev_b32 v2, 4, v1
  s_mov_b64 exec, s[68:69]
  buffer_store_dword v192, v2, s[12:15], s53 offen sc1
  s_add_u32 s53, s53, 4096
  buffer_store_dword v208, v2, s[12:15], s53 offen sc1
  s_add_u32 s53, s53, 4096
  buffer_store_dword v224, v2, s[12:15], s53 offen sc1
  s_mov_b64 exec, -1
L_css_15:
  s_waitcnt lgkmcnt(0)
  v_mfma_f32_32x32x16_bf16 v[96:111], v[76:79], v[56:59], v[96:111]
  s_waitcnt vmcnt(12)
  s_barrier
  s_add_u32 s53, s44, 4
  s_and_b32 s53, s53, 7
  s_lshl_b32 s47, s53, 7
  s_mul_i32 s48, s53, s62
  s_add_u32 s49, s48, s63
  ds_read_b128 v[48:51], v32 offset:0
  ds_read_b64_tr_b16 v[64:65], v36 offset:0
  v_mfma_f32_32x32x16_bf16 v[112:127], v[76:79], v[60:63], v[112:127]
  ds_read_b64_tr_b16 v[66:67], v36 offset:1536
  ds_read_b128 v[52:55], v32 offset:4096
  v_add_u32 v32, 0xfffec000, v32
  v_mfma_f32_32x32x16_bf16 v[144:159], v[80:83], v[60:63], v[144:159]
  ds_read_b64_tr_b16 v[68:69], v36 offset:512
  ds_read_b64_tr_b16 v[70:71], v36 offset:2048
  v_mfma_f32_32x32x16_bf16 v[128:143], v[80:83], v[56:59], v[128:143]
  ds_read_b64_tr_b16 v[72:73], v36 offset:1024
  ds_read_b64_tr_b16 v[74:75], v36 offset:2560
  s_add_u32 m0, s50, 40960
  v_mfma_f32_32x32x16_bf16 v[160:175], v[84:87], v[56:59], v[160:175]
  buffer_load_dwordx4 v24, s[4:7], s47 offen lds
  s_add_u32 m0, s50, 41984
  v_mfma_f32_32x32x16_bf16 v[176:191], v[84:87], v[60:63], v[176:191]
  buffer_load_dwordx4 v25, s[4:7], s47 offen lds
  s_waitcnt lgkmcnt(4)
  v_mfma_f32_32x32x16_bf16 v[96:111], v[64:67], v[48:51], v[96:111]
  ds_read_b128 v[56:59], v33 offset:0
  ds_read_b64_tr_b16 v[76:77], v36 offset:6144
  v_mfma_f32_32x32x16_bf16 v[112:127], v[64:67], v[52:55], v[112:127]
  ds_read_b64_tr_b16 v[78:79], v36 offset:7680
  ds_read_b128 v[60:63], v33 offset:4096
  v_add_u32 v33, 0xfffec000, v33
  s_waitcnt lgkmcnt(6)
  v_mfma_f32_32x32x16_bf16 v[144:159], v[68:71], v[52:55], v[144:159]
  ds_read_b64_tr_b16 v[80:81], v36 offset:6656
  ds_read_b64_tr_b16 v[82:83], v36 offset:8192
  s_add_u32 m0, s50, 43008
  v_mfma_f32_32x32x16_bf16 v[128:143], v[68:71], v[48:51], v[128:143]
  ds_read_b64_tr_b16 v[84:85], v36 offset:7168
  ds_read_b64_tr_b16 v[86:87], v36 offset:8704
  v_add_u32 v36, 0xfffec000, v36
  buffer_load_dwordx4 v26, s[4:7], s47 offen lds
  s_waitcnt lgkmcnt(8)
  s_add_u32 m0, s50, 44032
  v_mfma_f32_32x32x16_bf16 v[160:175], v[72:75], v[48:51], v[160:175]
  buffer_load_dwordx4 v27, s[4:7], s47 offen lds
  s_cmp_eq_u32 s1, 1
  s_cbranch_scc0 L_sp3_16
  s_add_u32 s54, s44, 5
  s_and_b32 s54, s54, 7
  s_mul_i32 s54, s54, s62
  s_mov_b32 exec_lo, 0xff
  s_mov_b32 exec_hi, 0
  buffer_load_dword v94, v93, s[8:11], s54 offen
  s_mov_b64 exec, -1
L_sp3_16:
  s_add_u32 m0, s51, 40960
  v_mfma_f32_32x32x16_bf16 v[176:191], v[72:75], v[52:55], v[176:191]
  buffer_load_dwordx4 v28, s[8:11], s48 offen lds
  ds_read_b64_tr_b16 v[16:17], v92 offset:0
  ds_read_b64_tr_b16 v[18:19], v92 offset:128
  ds_read_b64_tr_b16 v[20:21], v92 offset:256
  ds_read_b64_tr_b16 v[22:23], v92 offset:384
  s_waitcnt lgkmcnt(8)
  v_mfma_f32_32x32x16_bf16 v[96:111], v[76:79], v[56:59], v[96:111]
  ds_read_b128 v[48:51], v34 offset:0
  ds_read_b64_tr_b16 v[64:65], v37 offset:0
  s_lshr_b32 s53, s2, 3
  s_lshl_b32 s53, s53, 2
  s_add_u32 s53, s53, s36
  s_lshl_b32 s53, s53, 10
  v_bfe_u32 v2, v1, 3, 2
  v_lshlrev_b32 v2, 17, v2
  v_and_b32 v4, 7, v1
  v_lshl_or_b32 v2, v4, 7, v2
  s_mov_b32 exec_lo, 0xffff0000
  s_mov_b32 exec_hi, 0
  buffer_load_dword v252, v2, s[16:19], s53 offen
  s_mov_b64 exec, -1
  v_mfma_f32_32x32x16_bf16 v[112:127], v[76:79], v[60:63], v[112:127]
  ds_read_b64_tr_b16 v[66:67], v37 offset:1536
  ds_read_b128 v[52:55], v34 offset:4096
  v_add_u32 v34, 0xfffec000, v34
  s_waitcnt lgkmcnt(10)
  v_mfma_f32_32x32x16_bf16 v[144:159], v[80:83], v[60:63], v[144:159]
  ds_read_b64_tr_b16 v[68:69], v37 offset:512
  ds_read_b64_tr_b16 v[70:71], v37 offset:2048
  s_add_u32 m0, s51, 41984
  v_mfma_f32_32x32x16_bf16 v[128:143], v[80:83], v[56:59], v[128:143]
  ds_read_b64_tr_b16 v[72:73], v37 offset:1024
  ds_read_b64_tr_b16 v[74:75], v37 offset:2560
  buffer_load_dwordx4 v29, s[8:11], s48 offen lds
  s_waitcnt lgkmcnt(12)
  s_add_u32 m0, s51, 43008
  v_mfma_f32_32x32x16_bf16 v[160:175], v[84:87], v[56:59], v[160:175]
  buffer_load_dwordx4 v30, s[8:11], s48 offen lds
  s_add_u32 m0, s51, 44032
  v_mfma_f32_32x32x16_bf16 v[176:191], v[84:87], v[60:63], v[176:191]
  buffer_load_dwordx4 v28, s[8:11], s49 offen lds
  s_waitcnt lgkmcnt(4)
  v_mfma_f32_32x32x16_bf16 v[96:111], v[64:67], v[48:51], v[96:111]
  ds_read_b128 v[56:59], v35 offset:0
  ds_read_b64_tr_b16 v[76:77], v37 offset:6144
  v_lshrrev_b32 v246, 5, v1
  v_bfe_u32 v247, v1, 2, 2
  v_lshlrev_b32_e64 v247, 6, v247
  v_mfma_f32_32x32x16_bf16 v[112:127], v[64:67], v[52:55], v[112:127]
  ds_read_b64_tr_b16 v[78:79], v37 offset:7680
  ds_read_b128 v[60:63], v35 offset:4096
  v_add_u32 v35, 0xfffec000, v35
  v_and_b32_e64 v248, 1, v1
  v_lshl_or_b32 v247, v248, 5, v247
  v_bfe_u32 v248, v1, 4, 1
  s_waitcnt lgkmcnt(6)
  v_mfma_f32_32x32x16_bf16 v[144:159], v[68:71], v[52:55], v[144:159]
  ds_read_b64_tr_b16 v[80:81], v37 offset:6656
  ds_read_b64_tr_b16 v[82:83], v37 offset:8192
  v_lshl_or_b32 v247, v248, 4, v247
  v_bfe_u32 v248, v1, 1, 1
  v_lshl_or_b32 v247, v248, 3, v247
  v_mfma_f32_32x32x16_bf16 v[128:143], v[68:71], v[48:51], v[128:143]
  ds_read_b64_tr_b16 v[84:85], v37 offset:7168
  ds_read_b64_tr_b16 v[86:87], v37 offset:8704
  v_add_u32 v37, 0xfffec000, v37
  v_lshl_add_u32 v248, v246, 11, v247
  s_lshl_b32 s100, s42, 10
  v_add_u32 v38, s100, v248
  s_waitcnt lgkmcnt(8)
  s_add_u32 m0, s51, 45056
  v_mfma_f32_32x32x16_bf16 v[160:175], v[72:75], v[48:51], v[160:175]
  buffer_load_dwordx4 v29, s[8:11], s49 offen lds
  v_add_u32 v39, 0x10000, v38
  v_add_u32 v40, 0x20000, v38
  v_bfe_u32 v247, v1, 2, 2
  s_add_u32 m0, s51, 46080
  v_mfma_f32_32x32x16_bf16 v[176:191], v[72:75], v[52:55], v[176:191]
  buffer_load_dwordx4 v30, s[8:11], s49 offen lds
  v_lshl_add_u32 v247, v246, 2, v247
  s_lshl_b32 s100, s36, 3
  v_add_u32_e64 v247, s100, v247
  s_waitcnt lgkmcnt(0)
  v_mfma_f32_32x32x16_bf16 v[96:111], v[76:79], v[56:59], v[96:111]
  s_waitcnt vmcnt(11)
  s_barrier
  s_cmp_eq_u32 s36, 0
  s_cbranch_scc0 L_sg_17
  v_cmp_ne_u32 vcc, 1, v3
  s_cbranch_vccz L_bootd_19
  s_mov_b32 s60, 0
L_boot_18:
  buffer_load_dword v13, v12, s[32:35], 0 offen sc1
  s_add_u32 s60, s60, 1
  s_waitcnt vmcnt(0)
  v_cmp_ne_u32 vcc, 1, v13
  s_cmp_gt_u32 s60, 0x20000
  s_cbranch_scc1 L_bootd_19
  s_cbranch_vccnz L_boot_18
L_bootd_19:
  s_lshl_b32 s53, s37, 7
  s_lshl_b32 s54, s38, 7
  s_add_u32 s54, s54, 2048
  v_mov_b32_e64 v14, s53
  v_writelane_b32 v14, s54, 1
  v_mov_b32 v15, 1
  s_mov_b64 exec, 3
  buffer_atomic_add v15, v14, s[12:15], 0 offen sc1
  s_mov_b64 exec, -1
L_sg_17:
  s_add_u32 s53, s44, 5
  s_and_b32 s53, s53, 7
  s_lshl_b32 s47, s53, 7
  s_mul_i32 s48, s53, s62
  s_add_u32 s49, s48, s63
  ds_read_b128 v[48:51], v32 offset:0
  ds_read_b64_tr_b16 v[64:65], v36 offset:0
  v_lshlrev_b32_e64 v247, 10, v247
  v_bfe_u32 v248, v1, 4, 1
  v_lshl_or_b32 v247, v248, 6, v247
  v_mfma_f32_32x32x16_bf16 v[112:127], v[76:79], v[60:63], v[112:127]
  ds_read_b64_tr_b16 v[66:67], v36 offset:1536
  ds_read_b128 v[52:55], v32 offset:4096
  v_add_u32 v32, 0xa000, v32
  v_and_b32_e64 v248, 3, v1
  v_lshl_or_b32 v247, v248, 4, v247
  s_lshl_b32 s100, s39, 7
  v_mfma_f32_32x32x16_bf16 v[144:159], v[80:83], v[60:63], v[144:159]
  ds_read_b64_tr_b16 v[68:69], v36 offset:512
  ds_read_b64_tr_b16 v[70:71], v36 offset:2048
  v_add_u32 v31, s100, v247
  v_and_b32 v245, 31, v1
  v_lshrrev_b32 v246, 5, v1
  v_mfma_f32_32x32x16_bf16 v[128:143], v[80:83], v[56:59], v[128:143]
  ds_read_b64_tr_b16 v[72:73], v36 offset:1024
  ds_read_b64_tr_b16 v[74:75], v36 offset:2560
  s_lshl_b32 s100, s36, 12
  s_add_u32 s100, s100, 131072
  v_lshlrev_b32 v247, 6, v245
  s_add_u32 m0, s50, 81920
  v_mfma_f32_32x32x16_bf16 v[160:175], v[84:87], v[56:59], v[160:175]
  buffer_load_dwordx4 v24, s[4:7], s47 offen lds
  v_lshl_or_b32 v247, v246, 11, v247
  v_bfe_u32 v248, v245, 1, 2
  v_lshl_or_b32 v247, v248, 4, v247
  s_add_u32 m0, s50, 82944
  v_mfma_f32_32x32x16_bf16 v[176:191], v[84:87], v[60:63], v[176:191]
  buffer_load_dwordx4 v25, s[4:7], s47 offen lds
  v_add_u32_e64 v240, s100, v247
  v_bfe_u32 v247, v1, 2, 2
  v_lshl_add_u32 v247, v246, 2, v247
  s_waitcnt lgkmcnt(4)
  v_mfma_f32_32x32x16_bf16 v[96:111], v[64:67], v[48:51], v[96:111]
  ds_read_b128 v[56:59], v33 offset:0
  ds_read_b64_tr_b16 v[76:77], v36 offset:6144
  v_bfe_u32 v248, v247, 1, 2
  v_bfe_u32 v249, v1, 4, 1
  v_bfe_u32 v250, v1, 1, 1
  v_mov_b32 v218, 0
  v_mov_b32 v219, 0
  v_mov_b32 v222, 0
  v_mov_b32 v223, 0
  v_mov_b32 v226, 0
  v_mov_b32_e64 v227, 0
  v_mfma_f32_32x32x16_bf16 v[112:127], v[64:67], v[52:55], v[112:127]
  ds_read_b64_tr_b16 v[78:79], v36 offset:7680
  ds_read_b128 v[60:63], v33 offset:4096
  v_add_u32 v33, 0xa000, v33
  v_lshl_or_b32 v249, v249, 1, v250
  v_xor_b32 v248, v248, v249
  v_lshlrev_b32_e64 v248, 4, v248
  s_waitcnt lgkmcnt(6)
  v_mfma_f32_32x32x16_bf16 v[144:159], v[68:71], v[52:55], v[144:159]
  ds_read_b64_tr_b16 v[80:81], v36 offset:6656
  ds_read_b64_tr_b16 v[82:83], v36 offset:8192
  v_lshl_or_b32 v248, v247, 6, v248
  v_and_b32_e64 v250, 1, v1
  v_lshl_or_b32 v248, v250, 3, v248
  s_add_u32 m0, s50, 83968
  v_mfma_f32_32x32x16_bf16 v[128:143], v[68:71], v[48:51], v[128:143]
  ds_read_b64_tr_b16 v[84:85], v36 offset:7168
  ds_read_b64_tr_b16 v[86:87], v36 offset:8704
  v_add_u32 v36, 0xa000, v36
  buffer_load_dwordx4 v26, s[4:7], s47 offen lds
  v_add_u32 v242, s100, v248
  s_lshl_b32 s101, s36, 11
  s_add_u32 s101, s101, 147456
  s_waitcnt lgkmcnt(8)
  s_add_u32 m0, s50, 84992
  v_mfma_f32_32x32x16_bf16 v[160:175], v[72:75], v[48:51], v[160:175]
  buffer_load_dwordx4 v27, s[4:7], s47 offen lds
  v_lshlrev_b32 v248, 5, v245
  v_lshl_or_b32 v248, v246, 10, v248
  v_bfe_u32 v250, v245, 2, 1
  s_cmp_eq_u32 s1, 1
  s_cbranch_scc0 L_sp3_20
  s_add_u32 s54, s44, 6
  s_and_b32 s54, s54, 7
  s_mul_i32 s54, s54, s62
  s_mov_b32 exec_lo, 0xff
  s_mov_b32 exec_hi, 0
  buffer_load_dword v94, v93, s[8:11], s54 offen
  s_mov_b64 exec, -1
L_sp3_20:
  s_add_u32 m0, s51, 81920
  v_mfma_f32_32x32x16_bf16 v[176:191], v[72:75], v[52:55], v[176:191]
  buffer_load_dwordx4 v28, s[8:11], s48 offen lds
  v_lshl_or_b32 v248, v250, 4, v248
  v_add_u32 v241, s101, v248
  v_bfe_u32 v248, v1, 4, 1
  s_waitcnt lgkmcnt(4)
  v_mfma_f32_32x32x16_bf16 v[96:111], v[76:79], v[56:59], v[96:111]
  ds_read_b128 v[48:51], v34 offset:0
  ds_read_b64_tr_b16 v[64:65], v37 offset:0
  v_xor_b32 v248, v248, v246
  v_lshlrev_b32_e64 v248, 4, v248
  v_lshl_or_b32 v248, v247, 5, v248
  v_mov_b32 v230, 0
  v_mov_b32 v231, 0
  v_mov_b32 v234, 0
  v_mov_b32 v235, 0
  s_lshr_b32 s53, s2, 3
  s_lshl_b32 s53, s53, 2
  s_add_u32 s53, s53, s36
  s_lshl_b32 s53, s53, 10
  s_add_u32 s53, s53, 524288
  v_bfe_u32 v2, v1, 3, 2
  v_lshlrev_b32 v2, 17, v2
  v_and_b32 v4, 7, v1
  v_lshl_or_b32 v2, v4, 7, v2
  s_mov_b32 exec_lo, 0xffff
  s_mov_b32 exec_hi, 0
  buffer_load_dword v253, v2, s[16:19], s53 offen
  s_mov_b64 exec, -1
  v_mfma_f32_32x32x16_bf16 v[112:127], v[76:79], v[60:63], v[112:127]
  ds_read_b64_tr_b16 v[66:67], v37 offset:1536
  ds_read_b128 v[52:55], v34 offset:4096
  v_add_u32 v34, 0xa000, v34
  v_bfe_u32 v250, v1, 1, 1
  v_lshl_or_b32 v248, v250, 3, v248
  v_add_u32 v248, s101, v248
  s_waitcnt lgkmcnt(6)
  v_mfma_f32_32x32x16_bf16 v[144:159], v[80:83], v[60:63], v[144:159]
  ds_read_b64_tr_b16 v[68:69], v37 offset:512
  ds_read_b64_tr_b16 v[70:71], v37 offset:2048
  v_add_u32 v249, 1024, v248
  v_mov_b32 v250, 159744
  v_and_b32_e64 v251, 1, v1
  s_add_u32 m0, s51, 82944
  v_mfma_f32_32x32x16_bf16 v[128:143], v[80:83], v[56:59], v[128:143]
  ds_read_b64_tr_b16 v[72:73], v37 offset:1024
  ds_read_b64_tr_b16 v[74:75], v37 offset:2560
  buffer_load_dwordx4 v29, s[8:11], s48 offen lds
  v_cmp_eq_u32 vcc, 0, v251
  s_nop 1
  v_cndmask_b32 v243, v250, v248, vcc
  v_cndmask_b32 v244, v249, v250, vcc
  s_waitcnt lgkmcnt(8)
  s_add_u32 m0, s51, 83968
  v_mfma_f32_32x32x16_bf16 v[160:175], v[84:87], v[56:59], v[160:175]
  buffer_load_dwordx4 v30, s[8:11], s48 offen lds
  s_add_u32 m0, s51, 84992
  v_mfma_f32_32x32x16_bf16 v[176:191], v[84:87], v[60:63], v[176:191]
  buffer_load_dwordx4 v28, s[8:11], s49 offen lds
  s_waitcnt lgkmcnt(4)
  v_mfma_f32_32x32x16_bf16 v[96:111], v[64:67], v[48:51], v[96:111]
  ds_read_b128 v[56:59], v35 offset:0
  ds_read_b64_tr_b16 v[76:77], v37 offset:6144
  v_mfma_f32_32x32x16_bf16 v[112:127], v[64:67], v[52:55], v[112:127]
  ds_read_b64_tr_b16 v[78:79], v37 offset:7680
  ds_read_b128 v[60:63], v35 offset:4096
  v_add_u32 v35, 0xa000, v35
  s_waitcnt lgkmcnt(6)
  v_mfma_f32_32x32x16_bf16 v[144:159], v[68:71], v[52:55], v[144:159]
  ds_read_b64_tr_b16 v[80:81], v37 offset:6656
  ds_read_b64_tr_b16 v[82:83], v37 offset:8192
  v_mfma_f32_32x32x16_bf16 v[128:143], v[68:71], v[48:51], v[128:143]
  ds_read_b64_tr_b16 v[84:85], v37 offset:7168
  ds_read_b64_tr_b16 v[86:87], v37 offset:8704
  v_add_u32 v37, 0xa000, v37
  s_waitcnt lgkmcnt(8)
  s_add_u32 m0, s51, 86016
  v_mfma_f32_32x32x16_bf16 v[160:175], v[72:75], v[48:51], v[160:175]
  buffer_load_dwordx4 v29, s[8:11], s49 offen lds
  s_add_u32 m0, s51, 87040
  v_mfma_f32_32x32x16_bf16 v[176:191], v[72:75], v[52:55], v[176:191]
  buffer_load_dwordx4 v30, s[8:11], s49 offen lds
  s_waitcnt lgkmcnt(0)
  v_mfma_f32_32x32x16_bf16 v[96:111], v[76:79], v[56:59], v[96:111]
  s_waitcnt vmcnt(11)
  s_barrier
  s_add_u32 s53, s44, 6
  s_and_b32 s53, s53, 7
  s_lshl_b32 s47, s53, 7
  s_mul_i32 s48, s53, s62
  s_add_u32 s49, s48, s63
  ds_read_b128 v[48:51], v32 offset:0
  ds_read_b64_tr_b16 v[64:65], v36 offset:0
  v_mfma_f32_32x32x16_bf16 v[112:127], v[76:79], v[60:63], v[112:127]
  ds_read_b64_tr_b16 v[66:67], v36 offset:1536
  ds_read_b128 v[52:55], v32 offset:4096
  v_add_u32 v32, 0xa000, v32
  v_mfma_f32_32x32x16_bf16 v[144:159], v[80:83], v[60:63], v[144:159]
  ds_read_b64_tr_b16 v[68:69], v36 offset:512
  ds_read_b64_tr_b16 v[70:71], v36 offset:2048
  v_mfma_f32_32x32x16_bf16 v[128:143], v[80:83], v[56:59], v[128:143]
  ds_read_b64_tr_b16 v[72:73], v36 offset:1024
  ds_read_b64_tr_b16 v[74:75], v36 offset:2560
  s_add_u32 m0, s50, 0
  v_mfma_f32_32x32x16_bf16 v[160:175], v[84:87], v[56:59], v[160:175]
  buffer_load_dwordx4 v24, s[4:7], s47 offen lds
  s_add_u32 m0, s50, 1024
  v_mfma_f32_32x32x16_bf16 v[176:191], v[84:87], v[60:63], v[176:191]
  buffer_load_dwordx4 v25, s[4:7], s47 offen lds
  s_waitcnt lgkmcnt(4)
  v_mfma_f32_32x32x16_bf16 v[96:111], v[64:67], v[48:51], v[96:111]
  ds_read_b128 v[56:59], v33 offset:0
  ds_read_b64_tr_b16 v[76:77], v36 offset:6144
  v_mfma_f32_32x32x16_bf16 v[112:127], v[64:67], v[52:55], v[112:127]
  ds_read_b64_tr_b16 v[78:79], v36 offset:7680
  ds_read_b128 v[60:63], v33 offset:4096
  v_add_u32 v33, 0xa000, v33
  s_waitcnt lgkmcnt(6)
  v_mfma_f32_32x32x16_bf16 v[144:159], v[68:71], v[52:55], v[144:159]
  ds_read_b64_tr_b16 v[80:81], v36 offset:6656
  ds_read_b64_tr_b16 v[82:83], v36 offset:8192
  s_add_u32 m0, s50, 2048
  v_mfma_f32_32x32x16_bf16 v[128:143], v[68:71], v[48:51], v[128:143]
  ds_read_b64_tr_b16 v[84:85], v36 offset:7168
  ds_read_b64_tr_b16 v[86:87], v36 offset:8704
  v_add_u32 v36, 0xa000, v36
  buffer_load_dwordx4 v26, s[4:7], s47 offen lds
  s_waitcnt lgkmcnt(8)
  s_add_u32 m0, s50, 3072
  v_mfma_f32_32x32x16_bf16 v[160:175], v[72:75], v[48:51], v[160:175]
  buffer_load_dwordx4 v27, s[4:7], s47 offen lds
  s_cmp_eq_u32 s1, 1
  s_cbranch_scc0 L_sp3_21
  s_add_u32 s54, s44, 7
  s_and_b32 s54, s54, 7
  s_mul_i32 s54, s54, s62
  s_mov_b32 exec_lo, 0xff
  s_mov_b32 exec_hi, 0
  buffer_load_dword v94, v93, s[8:11], s54 offen
  s_mov_b64 exec, -1
L_sp3_21:
  s_add_u32 m0, s51, 0
  v_mfma_f32_32x32x16_bf16 v[176:191], v[72:75], v[52:55], v[176:191]
  buffer_load_dwordx4 v28, s[8:11], s48 offen lds
  s_waitcnt lgkmcnt(4)
  v_mfma_f32_32x32x16_bf16 v[96:111], v[76:79], v[56:59], v[96:111]
  ds_read_b128 v[48:51], v34 offset:0
  ds_read_b64_tr_b16 v[64:65], v37 offset:0
  s_lshr_b32 s53, s2, 3
  s_lshl_b32 s53, s53, 2
  s_add_u32 s53, s53, s36
  s_lshl_b32 s53, s53, 10
  s_add_u32 s53, s53, 524288
  v_bfe_u32 v2, v1, 3, 2
  v_lshlrev_b32 v2, 17, v2
  v_and_b32_e64 v4, 7, v1
  v_lshl_or_b32 v2, v4, 7, v2
  s_mov_b32 exec_lo, 0xffff0000
  s_mov_b32 exec_hi, 0
  buffer_load_dword v253, v2, s[16:19], s53 offen
  s_mov_b64 exec, -1
  v_mfma_f32_32x32x16_bf16 v[112:127], v[76:79], v[60:63], v[112:127]
  ds_read_b64_tr_b16 v[66:67], v37 offset:1536
  ds_read_b128 v[52:55], v34 offset:4096
  v_add_u32 v34, 0xa000, v34
  s_waitcnt lgkmcnt(6)
  v_mfma_f32_32x32x16_bf16 v[144:159], v[80:83], v[60:63], v[144:159]
  ds_read_b64_tr_b16 v[68:69], v37 offset:512
  ds_read_b64_tr_b16 v[70:71], v37 offset:2048
  s_add_u32 m0, s51, 1024
  v_mfma_f32_32x32x16_bf16 v[128:143], v[80:83], v[56:59], v[128:143]
  ds_read_b64_tr_b16 v[72:73], v37 offset:1024
  ds_read_b64_tr_b16 v[74:75], v37 offset:2560
  buffer_load_dwordx4 v29, s[8:11], s48 offen lds
  s_waitcnt lgkmcnt(8)
  s_add_u32 m0, s51, 2048
  v_mfma_f32_32x32x16_bf16 v[160:175], v[84:87], v[56:59], v[160:175]
  buffer_load_dwordx4 v30, s[8:11], s48 offen lds
  s_add_u32 m0, s51, 3072
  v_mfma_f32_32x32x16_bf16 v[176:191], v[84:87], v[60:63], v[176:191]
  buffer_load_dwordx4 v28, s[8:11], s49 offen lds
  s_waitcnt lgkmcnt(4)
  v_mfma_f32_32x32x16_bf16 v[96:111], v[64:67], v[48:51], v[96:111]
  ds_read_b128 v[56:59], v35 offset:0
  ds_read_b64_tr_b16 v[76:77], v37 offset:6144
  v_mfma_f32_32x32x16_bf16 v[112:127], v[64:67], v[52:55], v[112:127]
  ds_read_b64_tr_b16 v[78:79], v37 offset:7680
  ds_read_b128 v[60:63], v35 offset:4096
  v_add_u32 v35, 0xa000, v35
  s_waitcnt lgkmcnt(6)
  v_mfma_f32_32x32x16_bf16 v[144:159], v[68:71], v[52:55], v[144:159]
  ds_read_b64_tr_b16 v[80:81], v37 offset:6656
  ds_read_b64_tr_b16 v[82:83], v37 offset:8192
  v_mfma_f32_32x32x16_bf16 v[128:143], v[68:71], v[48:51], v[128:143]
  ds_read_b64_tr_b16 v[84:85], v37 offset:7168
  ds_read_b64_tr_b16 v[86:87], v37 offset:8704
  v_add_u32 v37, 0xa000, v37
  s_waitcnt lgkmcnt(8)
  s_add_u32 m0, s51, 4096
  v_mfma_f32_32x32x16_bf16 v[160:175], v[72:75], v[48:51], v[160:175]
  buffer_load_dwordx4 v29, s[8:11], s49 offen lds
  s_add_u32 m0, s51, 5120
  v_mfma_f32_32x32x16_bf16 v[176:191], v[72:75], v[52:55], v[176:191]
  buffer_load_dwordx4 v30, s[8:11], s49 offen lds
  s_waitcnt lgkmcnt(0)
  v_mfma_f32_32x32x16_bf16 v[96:111], v[76:79], v[56:59], v[96:111]
  s_waitcnt vmcnt(11)
  s_barrier
  s_lshl_b32 s53, s37, 7
  s_lshl_b32 s54, s38, 7
  s_add_u32 s54, s54, 2048
  v_mov_b32 v12, s53
  v_mov_b32 v2, s54
  v_and_b32 v4, 1, v1
  v_cmp_eq_u32 vcc, 1, v4
  s_nop 1
  v_cndmask_b32 v12, v12, v2, vcc
  buffer_load_dword v3, v12, s[12:15], 0 offen sc1
  s_add_u32 s53, s44, 7
  s_and_b32 s53, s53, 7
  s_lshl_b32 s47, s53, 7
  s_mul_i32 s48, s53, s62
  s_add_u32 s49, s48, s63
  ds_read_b128 v[48:51], v32 offset:0
  ds_read_b64_tr_b16 v[64:65], v36 offset:0
  v_mfma_f32_32x32x16_bf16 v[112:127], v[76:79], v[60:63], v[112:127]
  ds_read_b64_tr_b16 v[66:67], v36 offset:1536
  ds_read_b128 v[52:55], v32 offset:4096
  v_add_u32 v32, 0xfffec000, v32
  v_mfma_f32_32x32x16_bf16 v[144:159], v[80:83], v[60:63], v[144:159]
  ds_read_b64_tr_b16 v[68:69], v36 offset:512
  ds_read_b64_tr_b16 v[70:71], v36 offset:2048
  v_mfma_f32_32x32x16_bf16 v[128:143], v[80:83], v[56:59], v[128:143]
  ds_read_b64_tr_b16 v[72:73], v36 offset:1024
  ds_read_b64_tr_b16 v[74:75], v36 offset:2560
  s_add_u32 m0, s50, 40960
  v_mfma_f32_32x32x16_bf16 v[160:175], v[84:87], v[56:59], v[160:175]
  buffer_load_dwordx4 v24, s[4:7], s47 offen lds
  s_add_u32 m0, s50, 41984
  v_mfma_f32_32x32x16_bf16 v[176:191], v[84:87], v[60:63], v[176:191]
  buffer_load_dwordx4 v25, s[4:7], s47 offen lds
  s_waitcnt lgkmcnt(4)
  v_mfma_f32_32x32x16_bf16 v[96:111], v[64:67], v[48:51], v[96:111]
  ds_read_b128 v[56:59], v33 offset:0
  ds_read_b64_tr_b16 v[76:77], v36 offset:6144
  v_mfma_f32_32x32x16_bf16 v[112:127], v[64:67], v[52:55], v[112:127]
  ds_read_b64_tr_b16 v[78:79], v36 offset:7680
  ds_read_b128 v[60:63], v33 offset:4096
  v_add_u32 v33, 0xfffec000, v33
  s_waitcnt lgkmcnt(6)
  v_mfma_f32_32x32x16_bf16 v[144:159], v[68:71], v[52:55], v[144:159]
  ds_read_b64_tr_b16 v[80:81], v36 offset:6656
  ds_read_b64_tr_b16 v[82:83], v36 offset:8192
  s_add_u32 m0, s50, 43008
  v_mfma_f32_32x32x16_bf16 v[128:143], v[68:71], v[48:51], v[128:143]
  ds_read_b64_tr_b16 v[84:85], v36 offset:7168
  ds_read_b64_tr_b16 v[86:87], v36 offset:8704
  v_add_u32 v36, 0xfffec000, v36
  buffer_load_dwordx4 v26, s[4:7], s47 offen lds
  s_waitcnt lgkmcnt(8)
  s_add_u32 m0, s50, 44032
  v_mfma_f32_32x32x16_bf16 v[160:175], v[72:75], v[48:51], v[160:175]
  buffer_load_dwordx4 v27, s[4:7], s47 offen lds
  s_add_u32 m0, s51, 40960
  v_mfma_f32_32x32x16_bf16 v[176:191], v[72:75], v[52:55], v[176:191]
  buffer_load_dwordx4 v28, s[8:11], s48 offen lds
  s_waitcnt lgkmcnt(4)
  v_mfma_f32_32x32x16_bf16 v[96:111], v[76:79], v[56:59], v[96:111]
  ds_read_b128 v[48:51], v34 offset:0
  ds_read_b64_tr_b16 v[64:65], v37 offset:0
  v_mfma_f32_32x32x16_bf16 v[112:127], v[76:79], v[60:63], v[112:127]
  ds_read_b64_tr_b16 v[66:67], v37 offset:1536
  ds_read_b128 v[52:55], v34 offset:4096
  v_add_u32 v34, 0xfffec000, v34
  s_waitcnt lgkmcnt(6)
  v_mfma_f32_32x32x16_bf16 v[144:159], v[80:83], v[60:63], v[144:159]
  ds_read_b64_tr_b16 v[68:69], v37 offset:512
  ds_read_b64_tr_b16 v[70:71], v37 offset:2048
  s_add_u32 m0, s51, 41984
  v_mfma_f32_32x32x16_bf16 v[128:143], v[80:83], v[56:59], v[128:143]
  ds_read_b64_tr_b16 v[72:73], v37 offset:1024
  ds_read_b64_tr_b16 v[74:75], v37 offset:2560
  buffer_load_dwordx4 v29, s[8:11], s48 offen lds
  s_waitcnt lgkmcnt(8)
  s_add_u32 m0, s51, 43008
  v_mfma_f32_32x32x16_bf16 v[160:175], v[84:87], v[56:59], v[160:175]
  buffer_load_dwordx4 v30, s[8:11], s48 offen lds
  s_add_u32 m0, s51, 44032
  v_mfma_f32_32x32x16_bf16 v[176:191], v[84:87], v[60:63], v[176:191]
  buffer_load_dwordx4 v28, s[8:11], s49 offen lds
  s_waitcnt lgkmcnt(4)
  v_mfma_f32_32x32x16_bf16 v[96:111], v[64:67], v[48:51], v[96:111]
  ds_read_b128 v[56:59], v35 offset:0
  ds_read_b64_tr_b16 v[76:77], v37 offset:6144
  v_mfma_f32_32x32x16_bf16 v[112:127], v[64:67], v[52:55], v[112:127]
  ds_read_b64_tr_b16 v[78:79], v37 offset:7680
  ds_read_b128 v[60:63], v35 offset:4096
  v_add_u32 v35, 0xfffec000, v35
  s_waitcnt lgkmcnt(6)
  v_mfma_f32_32x32x16_bf16 v[144:159], v[68:71], v[52:55], v[144:159]
  ds_read_b64_tr_b16 v[80:81], v37 offset:6656
  ds_read_b64_tr_b16 v[82:83], v37 offset:8192
  v_mfma_f32_32x32x16_bf16 v[128:143], v[68:71], v[48:51], v[128:143]
  ds_read_b64_tr_b16 v[84:85], v37 offset:7168
  ds_read_b64_tr_b16 v[86:87], v37 offset:8704
  v_add_u32 v37, 0xfffec000, v37
  s_waitcnt lgkmcnt(8)
  s_add_u32 m0, s51, 45056
  v_mfma_f32_32x32x16_bf16 v[160:175], v[72:75], v[48:51], v[160:175]
  buffer_load_dwordx4 v29, s[8:11], s49 offen lds
  s_add_u32 m0, s51, 46080
  v_mfma_f32_32x32x16_bf16 v[176:191], v[72:75], v[52:55], v[176:191]
  buffer_load_dwordx4 v30, s[8:11], s49 offen lds
  s_waitcnt lgkmcnt(0)
  v_mfma_f32_32x32x16_bf16 v[96:111], v[76:79], v[56:59], v[96:111]
  s_waitcnt vmcnt(10)
  s_barrier
  v_cmp_ne_u32 vcc, 16, v3
  s_cbranch_vccz L_statd_23
  s_mov_b32 s60, 0
L_stat_22:
  buffer_load_dword v13, v12, s[12:15], 0 offen sc1
  s_add_u32 s60, s60, 1
  s_waitcnt vmcnt(0)
  v_cmp_ne_u32 vcc, 16, v13
  s_cmp_gt_u32 s60, 0x20000
  s_cbranch_scc1 L_statd_23
  s_cbranch_vccnz L_stat_22
L_statd_23:
  ds_read_b128 v[48:51], v32 offset:0
  ds_read_b64_tr_b16 v[64:65], v36 offset:0
  v_mfma_f32_32x32x16_bf16 v[112:127], v[76:79], v[60:63], v[112:127]
  ds_read_b64_tr_b16 v[66:67], v36 offset:1536
  ds_read_b128 v[52:55], v32 offset:4096
  v_add_u32 v32, 0xa000, v32
  s_lshl_b32 s53, s37, 7
  s_lshl_b32 s54, s41, 6
  s_add_u32 s53, s53, s54
  s_lshl_b32 s53, s53, 2
  v_and_b32 v5, 31, v1
  v_lshl_add_u32 v5, v5, 2, s53
  s_mul_i32 s70, s38, 6
  s_add_u32 s70, s70, s42
  s_lshl_b32 s70, s70, 11
  s_add_u32 s70, s70, 147456
  v_mfma_f32_32x32x16_bf16 v[144:159], v[80:83], v[60:63], v[144:159]
  ds_read_b64_tr_b16 v[68:69], v36 offset:512
  ds_read_b64_tr_b16 v[70:71], v36 offset:2048
  s_mov_b32 s53, 131072
  buffer_load_dword v42, v5, s[12:15], s53 offen offset:0 sc1
  v_mfma_f32_32x32x16_bf16 v[128:143], v[80:83], v[56:59], v[128:143]
  ds_read_b64_tr_b16 v[72:73], v36 offset:1024
  ds_read_b64_tr_b16 v[74:75], v36 offset:2560
  v_mfma_f32_32x32x16_bf16 v[160:175], v[84:87], v[56:59], v[160:175]
  s_mov_b32 s53, 139264
  buffer_load_dword v44, v5, s[12:15], s53 offen offset:0 sc1
  v_mfma_f32_32x32x16_bf16 v[176:191], v[84:87], v[60:63], v[176:191]
  s_mov_b32 s53, 131072
  buffer_load_dword v43, v5, s[12:15], s53 offen offset:128 sc1
  s_waitcnt lgkmcnt(4)
  v_mfma_f32_32x32x16_bf16 v[96:111], v[64:67], v[48:51], v[96:111]
  ds_read_b128 v[56:59], v33 offset:0
  ds_read_b64_tr_b16 v[76:77], v36 offset:6144
  s_mov_b32 s53, 139264
  buffer_load_dword v46, v5, s[12:15], s53 offen offset:128 sc1
  v_mfma_f32_32x32x16_bf16 v[112:127], v[64:67], v[52:55], v[112:127]
  ds_read_b64_tr_b16 v[78:79], v36 offset:7680
  ds_read_b128 v[60:63], v33 offset:4096
  v_add_u32 v33, 0xa000, v33
  buffer_load_dwordx4 v[192:195], v41, s[12:15], s70 offen offset:0 sc1
  s_waitcnt lgkmcnt(6)
  v_mfma_f32_32x32x16_bf16 v[144:159], v[68:71], v[52:55], v[144:159]
  ds_read_b64_tr_b16 v[80:81], v36 offset:6656
  ds_read_b64_tr_b16 v[82:83], v36 offset:8192
  buffer_load_dwordx4 v[196:199], v41, s[12:15], s70 offen offset:1024 sc1
  s_add_u32 s70, s70, 4096
  v_mfma_f32_32x32x16_bf16 v[128:143], v[68:71], v[48:51], v[128:143]
  ds_read_b64_tr_b16 v[84:85], v36 offset:7168
  ds_read_b64_tr_b16 v[86:87], v36 offset:8704
  v_add_u32 v36, 0xa000, v36
  s_waitcnt lgkmcnt(8)
  v_mfma_f32_32x32x16_bf16 v[160:175], v[72:75], v[48:51], v[160:175]
  v_mfma_f32_32x32x16_bf16 v[176:191], v[72:75], v[52:55], v[176:191]
  s_waitcnt lgkmcnt(4)
  v_mfma_f32_32x32x16_bf16 v[96:111], v[76:79], v[56:59], v[96:111]
  ds_read_b128 v[48:51], v34 offset:0
  ds_read_b64_tr_b16 v[64:65], v37 offset:0
  buffer_load_dwordx4 v[200:203], v41, s[12:15], s70 offen offset:0 sc1
  v_mfma_f32_32x32x16_bf16 v[112:127], v[76:79], v[60:63], v[112:127]
  ds_read_b64_tr_b16 v[66:67], v37 offset:1536
  ds_read_b128 v[52:55], v34 offset:4096
  v_add_u32 v34, 0xa000, v34
  buffer_load_dwordx4 v[204:207], v41, s[12:15], s70 offen offset:1024 sc1
  s_add_u32 s70, s70, 4096
  s_waitcnt lgkmcnt(6)
  v_mfma_f32_32x32x16_bf16 v[144:159], v[80:83], v[60:63], v[144:159]
  ds_read_b64_tr_b16 v[68:69], v37 offset:512
  ds_read_b64_tr_b16 v[70:71], v37 offset:2048
  buffer_load_dwordx4 v[208:211], v41, s[12:15], s70 offen offset:0 sc1
  s_mov_b32 s59, 0
  s_add_u32 m0, s52, 122880
  v_mfma_f32_32x32x16_bf16 v[128:143], v[80:83], v[56:59], v[128:143]
  ds_read_b64_tr_b16 v[72:73], v37 offset:1024
  ds_read_b64_tr_b16 v[74:75], v37 offset:2560
  buffer_load_dwordx4 v31, s[16:19], s59 offen lds
  s_waitcnt lgkmcnt(8)
  s_mov_b32 s59, 32768
  s_add_u32 m0, s52, 126976
  v_mfma_f32_32x32x16_bf16 v[160:175], v[84:87], v[56:59], v[160:175]
  buffer_load_dwordx4 v31, s[16:19], s59 offen lds
  s_mov_b32 s59, 65536
  s_add_u32 m0, s52, 81920
  v_mfma_f32_32x32x16_bf16 v[176:191], v[84:87], v[60:63], v[176:191]
  buffer_load_dwordx4 v31, s[16:19], s59 offen lds
  s_waitcnt lgkmcnt(4)
  v_mfma_f32_32x32x16_bf16 v[96:111], v[64:67], v[48:51], v[96:111]
  ds_read_b128 v[56:59], v35 offset:0
  ds_read_b64_tr_b16 v[76:77], v37 offset:6144
  buffer_load_dwordx4 v[212:215], v41, s[12:15], s70 offen offset:1024 sc1
  v_mfma_f32_32x32x16_bf16 v[112:127], v[64:67], v[52:55], v[112:127]
  ds_read_b64_tr_b16 v[78:79], v37 offset:7680
  ds_read_b128 v[60:63], v35 offset:4096
  v_add_u32 v35, 0xa000, v35
  s_waitcnt lgkmcnt(6)
  v_mfma_f32_32x32x16_bf16 v[144:159], v[68:71], v[52:55], v[144:159]
  ds_read_b64_tr_b16 v[80:81], v37 offset:6656
  ds_read_b64_tr_b16 v[82:83], v37 offset:8192
  v_mfma_f32_32x32x16_bf16 v[128:143], v[68:71], v[48:51], v[128:143]
  ds_read_b64_tr_b16 v[84:85], v37 offset:7168
  ds_read_b64_tr_b16 v[86:87], v37 offset:8704
  v_add_u32 v37, 0xa000, v37
  s_waitcnt lgkmcnt(8)
  s_mov_b32 s59, 98304
  s_add_u32 m0, s52, 86016
  v_mfma_f32_32x32x16_bf16 v[160:175], v[72:75], v[48:51], v[160:175]
  buffer_load_dwordx4 v31, s[16:19], s59 offen lds
  v_mfma_f32_32x32x16_bf16 v[176:191], v[72:75], v[52:55], v[176:191]
  s_waitcnt lgkmcnt(0)
  v_mfma_f32_32x32x16_bf16 v[96:111], v[76:79], v[56:59], v[96:111]
  s_waitcnt vmcnt(14)
  s_barrier
  ds_read_b128 v[48:51], v32 offset:0
  ds_read_b64_tr_b16 v[64:65], v36 offset:0
  v_mfma_f32_32x32x16_bf16 v[112:127], v[76:79], v[60:63], v[112:127]
  ds_read_b64_tr_b16 v[66:67], v36 offset:1536
  ds_read_b128 v[52:55], v32 offset:4096
  v_mfma_f32_32x32x16_bf16 v[144:159], v[80:83], v[60:63], v[144:159]
  ds_read_b64_tr_b16 v[68:69], v36 offset:512
  ds_read_b64_tr_b16 v[70:71], v36 offset:2048
  s_lshr_b32 s53, s2, 3
  s_lshl_b32 s53, s53, 2
  s_add_u32 s53, s53, s36
  s_lshl_b32 s53, s53, 10
  s_add_u32 s53, s53, 1048576
  v_bfe_u32 v2, v1, 3, 2
  v_lshlrev_b32 v2, 17, v2
  v_and_b32 v4, 7, v1
  v_lshl_or_b32 v2, v4, 7, v2
  s_mov_b64 exec, s[68:69]
  buffer_load_dword v252, v2, s[16:19], s53 offen
  s_mov_b64 exec, -1
  v_mfma_f32_32x32x16_bf16 v[128:143], v[80:83], v[56:59], v[128:143]
  ds_read_b64_tr_b16 v[72:73], v36 offset:1024
  ds_read_b64_tr_b16 v[74:75], v36 offset:2560
  s_mov_b32 s59, 131072
  s_add_u32 m0, s52, 90112
  v_mfma_f32_32x32x16_bf16 v[160:175], v[84:87], v[56:59], v[160:175]
  buffer_load_dwordx4 v31, s[16:19], s59 offen lds
  s_mov_b32 s59, 163840
  s_add_u32 m0, s52, 94208
  v_mfma_f32_32x32x16_bf16 v[176:191], v[84:87], v[60:63], v[176:191]
  buffer_load_dwordx4 v31, s[16:19], s59 offen lds
  s_waitcnt lgkmcnt(4)
  v_mfma_f32_32x32x16_bf16 v[96:111], v[64:67], v[48:51], v[96:111]
  ds_read_b128 v[56:59], v33 offset:0
  ds_read_b64_tr_b16 v[76:77], v36 offset:6144
  v_mfma_f32_32x32x16_bf16 v[112:127], v[64:67], v[52:55], v[112:127]
  ds_read_b64_tr_b16 v[78:79], v36 offset:7680
  ds_read_b128 v[60:63], v33 offset:4096
  s_lshr_b32 s53, s2, 3
  s_lshl_b32 s53, s53, 2
  s_add_u32 s53, s53, s36
  s_lshl_b32 s53, s53, 10
  v_bfe_u32 v2, v1, 3, 2
  v_lshlrev_b32 v2, 17, v2
  v_and_b32_e64 v4, 7, v1
  v_lshl_or_b32 v2, v4, 7, v2
  s_mov_b64 exec, s[68:69]
  buffer_load_dword v253, v2, s[20:23], s53 offen
  s_mov_b64 exec, -1
  s_waitcnt lgkmcnt(6)
  v_mfma_f32_32x32x16_bf16 v[144:159], v[68:71], v[52:55], v[144:159]
  ds_read_b64_tr_b16 v[80:81], v36 offset:6656
  ds_read_b64_tr_b16 v[82:83], v36 offset:8192
  s_mov_b32 s59, 196608
  s_add_u32 m0, s52, 98304
  v_mfma_f32_32x32x16_bf16 v[128:143], v[68:71], v[48:51], v[128:143]
  ds_read_b64_tr_b16 v[84:85], v36 offset:7168
  ds_read_b64_tr_b16 v[86:87], v36 offset:8704
  buffer_load_dwordx4 v31, s[16:19], s59 offen lds
  s_waitcnt lgkmcnt(8)
  s_mov_b32 s59, 229376
  s_add_u32 m0, s52, 102400
  v_mfma_f32_32x32x16_bf16 v[160:175], v[72:75], v[48:51], v[160:175]
  buffer_load_dwordx4 v31, s[16:19], s59 offen lds
  s_mov_b32 s59, 262144
  s_add_u32 m0, s52, 106496
  v_mfma_f32_32x32x16_bf16 v[176:191], v[72:75], v[52:55], v[176:191]
  buffer_load_dwordx4 v31, s[16:19], s59 offen lds
  s_waitcnt lgkmcnt(4)
  v_mfma_f32_32x32x16_bf16 v[96:111], v[76:79], v[56:59], v[96:111]
  ds_read_b128 v[48:51], v34 offset:0
  ds_read_b64_tr_b16 v[64:65], v37 offset:0
  s_waitcnt vmcnt(8)
  v_add_f32 v192, v192, v193
  v_add_f32 v194, v194, v195
  v_add_f32 v196, v196, v197
  v_add_f32 v198, v198, v199
  v_mfma_f32_32x32x16_bf16 v[112:127], v[76:79], v[60:63], v[112:127]
  ds_read_b64_tr_b16 v[66:67], v37 offset:1536
  ds_read_b128 v[52:55], v34 offset:4096
  v_add_f32 v192, v192, v194
  v_add_f32 v196, v196, v198
  v_add_f32_e64 v192, v192, v196
  v_cvt_pk_bf16_f32 v216, v192, v192
  s_waitcnt lgkmcnt(6)
  v_mfma_f32_32x32x16_bf16 v[144:159], v[80:83], v[60:63], v[144:159]
  ds_read_b64_tr_b16 v[68:69], v37 offset:512
  ds_read_b64_tr_b16 v[70:71], v37 offset:2048
  v_and_b32 v193, 0xffff0000, v216
  v_sub_f32 v192, v192, v193
  v_cvt_pk_bf16_f32 v217, v192, v192
  s_mov_b32 s59, 294912
  s_add_u32 m0, s52, 110592
  v_mfma_f32_32x32x16_bf16 v[128:143], v[80:83], v[56:59], v[128:143]
  ds_read_b64_tr_b16 v[72:73], v37 offset:1024
  ds_read_b64_tr_b16 v[74:75], v37 offset:2560
  buffer_load_dwordx4 v31, s[16:19], s59 offen lds
  s_waitcnt lgkmcnt(8)
  s_mov_b32 s59, 327680
  s_add_u32 m0, s52, 114688
  v_mfma_f32_32x32x16_bf16 v[160:175], v[84:87], v[56:59], v[160:175]
  buffer_load_dwordx4 v31, s[16:19], s59 offen lds
  v_add_f32 v200, v200, v201
  v_add_f32 v202, v202, v203
  v_add_f32 v204, v204, v205
  v_add_f32_e64 v206, v206, v207
  s_mov_b32 s59, 360448
  s_add_u32 m0, s52, 118784
  v_mfma_f32_32x32x16_bf16 v[176:191], v[84:87], v[60:63], v[176:191]
  buffer_load_dwordx4 v31, s[16:19], s59 offen lds
  v_add_f32 v200, v200, v202
  v_add_f32 v204, v204, v206
  v_add_f32_e64 v200, v200, v204
  v_cvt_pk_bf16_f32 v220, v200, v200
  s_waitcnt lgkmcnt(4)
  v_mfma_f32_32x32x16_bf16 v[96:111], v[64:67], v[48:51], v[96:111]
  ds_read_b128 v[56:59], v35 offset:0
  ds_read_b64_tr_b16 v[76:77], v37 offset:6144
  v_and_b32 v201, 0xffff0000, v220
  v_sub_f32 v200, v200, v201
  v_cvt_pk_bf16_f32 v221, v200, v200
  v_mfma_f32_32x32x16_bf16 v[112:127], v[64:67], v[52:55], v[112:127]
  ds_read_b64_tr_b16 v[78:79], v37 offset:7680
  ds_read_b128 v[60:63], v35 offset:4096
  v_add_f32 v208, v208, v209
  v_add_f32 v210, v210, v211
  v_add_f32 v212, v212, v213
  v_add_f32_e64 v214, v214, v215
  s_waitcnt lgkmcnt(6)
  v_mfma_f32_32x32x16_bf16 v[144:159], v[68:71], v[52:55], v[144:159]
  ds_read_b64_tr_b16 v[80:81], v37 offset:6656
  ds_read_b64_tr_b16 v[82:83], v37 offset:8192
  v_add_f32 v208, v208, v210
  v_add_f32 v212, v212, v214
  v_add_f32_e64 v208, v208, v212
  v_cvt_pk_bf16_f32 v224, v208, v208
  v_mfma_f32_32x32x16_bf16 v[128:143], v[68:71], v[48:51], v[128:143]
  ds_read_b64_tr_b16 v[84:85], v37 offset:7168
  ds_read_b64_tr_b16 v[86:87], v37 offset:8704
  s_waitcnt lgkmcnt(8)
  s_mov_b32 s59, 393216
  s_add_u32 m0, s52, 0
  v_mfma_f32_32x32x16_bf16 v[160:175], v[72:75], v[48:51], v[160:175]
  buffer_load_dwordx4 v31, s[16:19], s59 offen lds
  v_and_b32 v209, 0xffff0000, v224
  v_sub_f32_e64 v208, v208, v209
  v_cvt_pk_bf16_f32 v225, v208, v208
  s_mov_b32 s59, 425984
  s_add_u32 m0, s52, 4096
  v_mfma_f32_32x32x16_bf16 v[176:191], v[72:75], v[52:55], v[176:191]
  buffer_load_dwordx4 v31, s[16:19], s59 offen lds
  v_sub_f32_e64 v42, 0, v42
  v_cvt_pk_bf16_f32 v228, v42, v42
  v_and_b32 v229, 0xffff0000, v228
  v_sub_f32_e64 v42, v42, v229
  v_cvt_pk_bf16_f32 v228, v229, v42
  v_mov_b32 v229, v228
  s_waitcnt lgkmcnt(0)
  v_mfma_f32_32x32x16_bf16 v[96:111], v[76:79], v[56:59], v[96:111]
  s_barrier
  v_mfma_f32_32x32x16_bf16 v[112:127], v[76:79], v[60:63], v[112:127]
  v_mfma_f32_32x32x16_bf16 v[144:159], v[80:83], v[60:63], v[144:159]
  v_sub_f32 v43, 0, v43
  v_cvt_pk_bf16_f32 v232, v43, v43
  v_and_b32 v233, 0xffff0000, v232
  v_sub_f32_e64 v43, v43, v233
  v_cvt_pk_bf16_f32 v232, v233, v43
  v_mov_b32_e64 v233, v232
  v_mfma_f32_32x32x16_bf16 v[128:143], v[80:83], v[56:59], v[128:143]
  s_mov_b32 s59, 458752
  s_add_u32 m0, s52, 8192
  v_mfma_f32_32x32x16_bf16 v[160:175], v[84:87], v[56:59], v[160:175]
  buffer_load_dwordx4 v31, s[16:19], s59 offen lds
  s_mov_b32 s59, 491520
  s_add_u32 m0, s52, 12288
  v_mfma_f32_32x32x16_bf16 v[176:191], v[84:87], v[60:63], v[176:191]
  buffer_load_dwordx4 v31, s[16:19], s59 offen lds
  v_mfma_f32_32x32x16_bf16 v[96:111], v[216:219], v[228:231], v[96:111]
  s_mov_b32 s59, 524288
  s_add_u32 m0, s52, 16384
  s_nop 0
  buffer_load_dwordx4 v31, s[16:19], s59 offen lds
  v_mfma_f32_32x32x16_bf16 v[112:127], v[216:219], v[232:235], v[112:127]
  s_mov_b32 s59, 557056
  s_add_u32 m0, s52, 20480
  s_nop 0
  buffer_load_dwordx4 v31, s[16:19], s59 offen lds
  v_mfma_f32_32x32x16_bf16 v[128:143], v[220:223], v[228:231], v[128:143]
  s_mov_b32 s59, 589824
  s_add_u32 m0, s52, 24576
  s_nop 0
  buffer_load_dwordx4 v31, s[16:19], s59 offen lds
  v_mfma_f32_32x32x16_bf16 v[144:159], v[220:223], v[232:235], v[144:159]
  s_mov_b32 s59, 622592
  s_add_u32 m0, s52, 28672
  s_nop 0
  buffer_load_dwordx4 v31, s[16:19], s59 offen lds
  v_mfma_f32_32x32x16_bf16 v[160:175], v[224:227], v[228:231], v[160:175]
  s_mov_b32 s59, 655360
  s_add_u32 m0, s52, 32768
  s_nop 0
  buffer_load_dwordx4 v31, s[16:19], s59 offen lds
  v_mfma_f32_32x32x16_bf16 v[176:191], v[224:227], v[232:235], v[176:191]
  s_mov_b32 s59, 688128
  s_add_u32 m0, s52, 36864
  s_nop 0
  buffer_load_dwordx4 v31, s[16:19], s59 offen lds
  s_cmp_eq_u32 s40, 0
  s_cbranch_scc1 L_att
  v_mul_f32 v2, 0xbfb8aa3b, v44
  v_rcp_f32_e64 v6, v44
  v_mul_f32 v4, 0xbfb8aa3b, v46
  v_rcp_f32_e64 v8, v46
  s_lshl_b32 s53, s37, 2
  s_lshl_b32 s54, s41, 1
  s_add_u32 s53, s53, s54
  s_add_u32 s53, s53, 0
  s_mul_i32 s53, s53, 118
  s_add_u32 s54, s61, s42
  s_lshl_b32 s54, s54, 1
  s_add_u32 s53, s53, s54
  s_lshl_b32 s53, s53, 10
  s_add_u32 s70, s53, 4194304
  s_lshl_b32 s53, s37, 2
  s_lshl_b32 s54, s41, 1
  s_add_u32 s53, s53, s54
  s_add_u32 s53, s53, 1
  s_mul_i32 s53, s53, 118
  s_add_u32 s54, s61, s42
  s_lshl_b32 s54, s54, 1
  s_add_u32 s53, s53, s54
  s_lshl_b32 s53, s53, 10
  s_add_u32 s71, s53, 4194304
  v_pk_mul_f32 v[192:193], v[96:97], v[2:3] op_sel_hi:[1,0]
  v_pk_mul_f32 v[194:195], v[98:99], v[2:3] op_sel_hi:[1,0]
  v_pk_mul_f32 v[196:197], v[100:101], v[2:3] op_sel_hi:[1,0]
  v_pk_mul_f32 v[198:199], v[102:103], v[2:3] op_sel_hi:[1,0]
  v_pk_mul_f32 v[200:201], v[104:105], v[2:3] op_sel_hi:[1,0]
  v_pk_mul_f32 v[202:203], v[106:107], v[2:3] op_sel_hi:[1,0]
  v_pk_mul_f32 v[204:205], v[108:109], v[2:3] op_sel_hi:[1,0]
  v_pk_mul_f32 v[206:207], v[110:111], v[2:3] op_sel_hi:[1,0]
  v_exp_f32 v192, v192
  v_exp_f32 v193, v193
  v_exp_f32 v194, v194
  v_exp_f32 v195, v195
  v_exp_f32 v196, v196
  v_exp_f32 v197, v197
  v_exp_f32 v198, v198
  v_exp_f32 v199, v199
  v_exp_f32 v200, v200
  v_exp_f32 v201, v201
  v_exp_f32 v202, v202
  v_exp_f32 v203, v203
  v_exp_f32 v204, v204
  v_exp_f32 v205, v205
  v_exp_f32 v206, v206
  v_exp_f32 v207, v207
  v_pk_fma_f32 v[192:193], v[192:193], v[6:7], v[6:7] op_sel_hi:[1,0,0]
  v_pk_fma_f32 v[194:195], v[194:195], v[6:7], v[6:7] op_sel_hi:[1,0,0]
  v_pk_fma_f32 v[196:197], v[196:197], v[6:7], v[6:7] op_sel_hi:[1,0,0]
  v_pk_fma_f32 v[198:199], v[198:199], v[6:7], v[6:7] op_sel_hi:[1,0,0]
  v_pk_fma_f32 v[200:201], v[200:201], v[6:7], v[6:7] op_sel_hi:[1,0,0]
  v_pk_fma_f32 v[202:203], v[202:203], v[6:7], v[6:7] op_sel_hi:[1,0,0]
  v_pk_fma_f32 v[204:205], v[204:205], v[6:7], v[6:7] op_sel_hi:[1,0,0]
  v_pk_fma_f32 v[206:207], v[206:207], v[6:7], v[6:7] op_sel_hi:[1,0,0]
  v_rcp_f32 v192, v192
  v_rcp_f32 v193, v193
  v_rcp_f32 v194, v194
  v_rcp_f32 v195, v195
  v_rcp_f32 v196, v196
  v_rcp_f32 v197, v197
  v_rcp_f32 v198, v198
  v_rcp_f32 v199, v199
  v_rcp_f32 v200, v200
  v_rcp_f32 v201, v201
  v_rcp_f32 v202, v202
  v_rcp_f32 v203, v203
  v_rcp_f32 v204, v204
  v_rcp_f32 v205, v205
  v_rcp_f32 v206, v206
  v_rcp_f32 v207, v207
  v_pk_mul_f32 v[96:97], v[96:97], v[192:193]
  v_pk_mul_f32 v[98:99], v[98:99], v[194:195]
  v_pk_mul_f32 v[100:101], v[100:101], v[196:197]
  v_pk_mul_f32 v[102:103], v[102:103], v[198:199]
  v_pk_mul_f32 v[104:105], v[104:105], v[200:201]
  v_pk_mul_f32 v[106:107], v[106:107], v[202:203]
  v_pk_mul_f32 v[108:109], v[108:109], v[204:205]
  v_pk_mul_f32 v[110:111], v[110:111], v[206:207]
  v_cvt_pk_bf16_f32 v96, v96, v97
  v_cvt_pk_bf16_f32 v97, v98, v99
  v_cvt_pk_bf16_f32 v98, v100, v101
  v_cvt_pk_bf16_f32 v99, v102, v103
  v_cvt_pk_bf16_f32 v100, v104, v105
  v_cvt_pk_bf16_f32 v101, v106, v107
  v_cvt_pk_bf16_f32 v102, v108, v109
  v_cvt_pk_bf16_f32 v103, v110, v111
  buffer_store_dwordx4 v[96:99], v41, s[12:15], s70 offen sc1
  buffer_store_dwordx4 v[100:103], v41, s[12:15], s70 offen offset:1024 sc1
  s_add_u32 s70, s70, 4096
  s_mov_b32 s59, 720896
  s_add_u32 m0, s52, 40960
  s_nop 0
  buffer_load_dwordx4 v31, s[16:19], s59 offen lds
  s_mov_b32 s59, 753664
  s_add_u32 m0, s52, 45056
  s_nop 0
  buffer_load_dwordx4 v31, s[16:19], s59 offen lds
  s_mov_b32 s59, 786432
  s_add_u32 m0, s52, 49152
  s_nop 0
  s_nop 0
  buffer_load_dwordx4 v31, s[16:19], s59 offen lds
  v_pk_mul_f32 v[192:193], v[112:113], v[4:5] op_sel_hi:[1,0]
  v_pk_mul_f32 v[194:195], v[114:115], v[4:5] op_sel_hi:[1,0]
  v_pk_mul_f32 v[196:197], v[116:117], v[4:5] op_sel_hi:[1,0]
  v_pk_mul_f32 v[198:199], v[118:119], v[4:5] op_sel_hi:[1,0]
  v_pk_mul_f32 v[200:201], v[120:121], v[4:5] op_sel_hi:[1,0]
  v_pk_mul_f32 v[202:203], v[122:123], v[4:5] op_sel_hi:[1,0]
  v_pk_mul_f32 v[204:205], v[124:125], v[4:5] op_sel_hi:[1,0]
  v_pk_mul_f32 v[206:207], v[126:127], v[4:5] op_sel_hi:[1,0]
  v_exp_f32 v192, v192
  v_exp_f32 v193, v193
  v_exp_f32 v194, v194
  v_exp_f32 v195, v195
  v_exp_f32 v196, v196
  v_exp_f32 v197, v197
  v_exp_f32 v198, v198
  v_exp_f32 v199, v199
  v_exp_f32 v200, v200
  v_exp_f32 v201, v201
  v_exp_f32 v202, v202
  v_exp_f32 v203, v203
  v_exp_f32 v204, v204
  v_exp_f32 v205, v205
  v_exp_f32 v206, v206
  v_exp_f32 v207, v207
  v_pk_fma_f32 v[192:193], v[192:193], v[8:9], v[8:9] op_sel_hi:[1,0,0]
  v_pk_fma_f32 v[194:195], v[194:195], v[8:9], v[8:9] op_sel_hi:[1,0,0]
  v_pk_fma_f32 v[196:197], v[196:197], v[8:9], v[8:9] op_sel_hi:[1,0,0]
  v_pk_fma_f32 v[198:199], v[198:199], v[8:9], v[8:9] op_sel_hi:[1,0,0]
  v_pk_fma_f32 v[200:201], v[200:201], v[8:9], v[8:9] op_sel_hi:[1,0,0]
  v_pk_fma_f32 v[202:203], v[202:203], v[8:9], v[8:9] op_sel_hi:[1,0,0]
  v_pk_fma_f32 v[204:205], v[204:205], v[8:9], v[8:9] op_sel_hi:[1,0,0]
  v_pk_fma_f32 v[206:207], v[206:207], v[8:9], v[8:9] op_sel_hi:[1,0,0]
  v_rcp_f32 v192, v192
  v_rcp_f32 v193, v193
  v_rcp_f32 v194, v194
  v_rcp_f32 v195, v195
  v_rcp_f32 v196, v196
  v_rcp_f32 v197, v197
  v_rcp_f32 v198, v198
  v_rcp_f32 v199, v199
  v_rcp_f32 v200, v200
  v_rcp_f32 v201, v201
  v_rcp_f32 v202, v202
  v_rcp_f32 v203, v203
  v_rcp_f32 v204, v204
  v_rcp_f32 v205, v205
  v_rcp_f32 v206, v206
  v_rcp_f32 v207, v207
  v_pk_mul_f32 v[112:113], v[112:113], v[192:193]
  v_pk_mul_f32 v[114:115], v[114:115], v[194:195]
  v_pk_mul_f32 v[116:117], v[116:117], v[196:197]
  v_pk_mul_f32 v[118:119], v[118:119], v[198:199]
  v_pk_mul_f32 v[120:121], v[120:121], v[200:201]
  v_pk_mul_f32 v[122:123], v[122:123], v[202:203]
  v_pk_mul_f32 v[124:125], v[124:125], v[204:205]
  v_pk_mul_f32 v[126:127], v[126:127], v[206:207]
  v_cvt_pk_bf16_f32 v112, v112, v113
  v_cvt_pk_bf16_f32 v113, v114, v115
  v_cvt_pk_bf16_f32 v114, v116, v117
  v_cvt_pk_bf16_f32 v115, v118, v119
  v_cvt_pk_bf16_f32 v116, v120, v121
  v_cvt_pk_bf16_f32 v117, v122, v123
  v_cvt_pk_bf16_f32 v118, v124, v125
  v_cvt_pk_bf16_f32 v119, v126, v127
  buffer_store_dwordx4 v[112:115], v41, s[12:15], s71 offen sc1
  buffer_store_dwordx4 v[116:119], v41, s[12:15], s71 offen offset:1024 sc1
  s_add_u32 s71, s71, 4096
  s_mov_b32 s59, 819200
  s_add_u32 m0, s52, 53248
  s_nop 0
  buffer_load_dwordx4 v31, s[16:19], s59 offen lds
  s_mov_b32 s59, 851968
  s_add_u32 m0, s52, 57344
  s_nop 0
  buffer_load_dwordx4 v31, s[16:19], s59 offen lds
  s_mov_b32 s59, 884736
  s_add_u32 m0, s52, 61440
  s_nop 0
  s_nop 0
  buffer_load_dwordx4 v31, s[16:19], s59 offen lds
  v_pk_mul_f32 v[192:193], v[128:129], v[2:3] op_sel_hi:[1,0]
  v_pk_mul_f32 v[194:195], v[130:131], v[2:3] op_sel_hi:[1,0]
  v_pk_mul_f32 v[196:197], v[132:133], v[2:3] op_sel_hi:[1,0]
  v_pk_mul_f32 v[198:199], v[134:135], v[2:3] op_sel_hi:[1,0]
  v_pk_mul_f32 v[200:201], v[136:137], v[2:3] op_sel_hi:[1,0]
  v_pk_mul_f32 v[202:203], v[138:139], v[2:3] op_sel_hi:[1,0]
  v_pk_mul_f32 v[204:205], v[140:141], v[2:3] op_sel_hi:[1,0]
  v_pk_mul_f32 v[206:207], v[142:143], v[2:3] op_sel_hi:[1,0]
  v_exp_f32 v192, v192
  v_exp_f32 v193, v193
  v_exp_f32 v194, v194
  v_exp_f32 v195, v195
  v_exp_f32 v196, v196
  v_exp_f32 v197, v197
  v_exp_f32 v198, v198
  v_exp_f32 v199, v199
  v_exp_f32 v200, v200
  v_exp_f32 v201, v201
  v_exp_f32 v202, v202
  v_exp_f32 v203, v203
  v_exp_f32 v204, v204
  v_exp_f32 v205, v205
  v_exp_f32 v206, v206
  v_exp_f32 v207, v207
  v_pk_fma_f32 v[192:193], v[192:193], v[6:7], v[6:7] op_sel_hi:[1,0,0]
  v_pk_fma_f32 v[194:195], v[194:195], v[6:7], v[6:7] op_sel_hi:[1,0,0]
  v_pk_fma_f32 v[196:197], v[196:197], v[6:7], v[6:7] op_sel_hi:[1,0,0]
  v_pk_fma_f32 v[198:199], v[198:199], v[6:7], v[6:7] op_sel_hi:[1,0,0]
  v_pk_fma_f32 v[200:201], v[200:201], v[6:7], v[6:7] op_sel_hi:[1,0,0]
  v_pk_fma_f32 v[202:203], v[202:203], v[6:7], v[6:7] op_sel_hi:[1,0,0]
  v_pk_fma_f32 v[204:205], v[204:205], v[6:7], v[6:7] op_sel_hi:[1,0,0]
  v_pk_fma_f32 v[206:207], v[206:207], v[6:7], v[6:7] op_sel_hi:[1,0,0]
  v_rcp_f32 v192, v192
  v_rcp_f32 v193, v193
  v_rcp_f32 v194, v194
  v_rcp_f32 v195, v195
  v_rcp_f32 v196, v196
  v_rcp_f32 v197, v197
  v_rcp_f32 v198, v198
  v_rcp_f32 v199, v199
  v_rcp_f32 v200, v200
  v_rcp_f32 v201, v201
  v_rcp_f32 v202, v202
  v_rcp_f32 v203, v203
  v_rcp_f32 v204, v204
  v_rcp_f32 v205, v205
  v_rcp_f32 v206, v206
  v_rcp_f32 v207, v207
  v_pk_mul_f32 v[128:129], v[128:129], v[192:193]
  v_pk_mul_f32 v[130:131], v[130:131], v[194:195]
  v_pk_mul_f32 v[132:133], v[132:133], v[196:197]
  v_pk_mul_f32 v[134:135], v[134:135], v[198:199]
  v_pk_mul_f32 v[136:137], v[136:137], v[200:201]
  v_pk_mul_f32 v[138:139], v[138:139], v[202:203]
  v_pk_mul_f32 v[140:141], v[140:141], v[204:205]
  v_pk_mul_f32 v[142:143], v[142:143], v[206:207]
  v_cvt_pk_bf16_f32 v128, v128, v129
  v_cvt_pk_bf16_f32 v129, v130, v131
  v_cvt_pk_bf16_f32 v130, v132, v133
  v_cvt_pk_bf16_f32 v131, v134, v135
  v_cvt_pk_bf16_f32 v132, v136, v137
  v_cvt_pk_bf16_f32 v133, v138, v139
  v_cvt_pk_bf16_f32 v134, v140, v141
  v_cvt_pk_bf16_f32 v135, v142, v143
  buffer_store_dwordx4 v[128:131], v41, s[12:15], s70 offen sc1
  buffer_store_dwordx4 v[132:135], v41, s[12:15], s70 offen offset:1024 sc1
  s_add_u32 s70, s70, 4096
  s_mov_b32 s59, 917504
  s_add_u32 m0, s52, 65536
  s_nop 0
  buffer_load_dwordx4 v31, s[16:19], s59 offen lds
  s_mov_b32 s59, 950272
  s_add_u32 m0, s52, 69632
  s_nop 0
  buffer_load_dwordx4 v31, s[16:19], s59 offen lds
  s_mov_b32 s59, 983040
  s_add_u32 m0, s52, 73728
  s_nop 0
  s_nop 0
  buffer_load_dwordx4 v31, s[16:19], s59 offen lds
  v_pk_mul_f32 v[192:193], v[144:145], v[4:5] op_sel_hi:[1,0]
  v_pk_mul_f32 v[194:195], v[146:147], v[4:5] op_sel_hi:[1,0]
  v_pk_mul_f32 v[196:197], v[148:149], v[4:5] op_sel_hi:[1,0]
  v_pk_mul_f32 v[198:199], v[150:151], v[4:5] op_sel_hi:[1,0]
  v_pk_mul_f32 v[200:201], v[152:153], v[4:5] op_sel_hi:[1,0]
  v_pk_mul_f32 v[202:203], v[154:155], v[4:5] op_sel_hi:[1,0]
  v_pk_mul_f32 v[204:205], v[156:157], v[4:5] op_sel_hi:[1,0]
  v_pk_mul_f32 v[206:207], v[158:159], v[4:5] op_sel_hi:[1,0]
  v_exp_f32 v192, v192
  v_exp_f32 v193, v193
  v_exp_f32 v194, v194
  v_exp_f32 v195, v195
  v_exp_f32 v196, v196
  v_exp_f32 v197, v197
  v_exp_f32 v198, v198
  v_exp_f32 v199, v199
  v_exp_f32 v200, v200
  v_exp_f32 v201, v201
  v_exp_f32 v202, v202
  v_exp_f32 v203, v203
  v_exp_f32 v204, v204
  v_exp_f32 v205, v205
  v_exp_f32 v206, v206
  v_exp_f32 v207, v207
  v_pk_fma_f32 v[192:193], v[192:193], v[8:9], v[8:9] op_sel_hi:[1,0,0]
  v_pk_fma_f32 v[194:195], v[194:195], v[8:9], v[8:9] op_sel_hi:[1,0,0]
  v_pk_fma_f32 v[196:197], v[196:197], v[8:9], v[8:9] op_sel_hi:[1,0,0]
  v_pk_fma_f32 v[198:199], v[198:199], v[8:9], v[8:9] op_sel_hi:[1,0,0]
  v_pk_fma_f32 v[200:201], v[200:201], v[8:9], v[8:9] op_sel_hi:[1,0,0]
  v_pk_fma_f32 v[202:203], v[202:203], v[8:9], v[8:9] op_sel_hi:[1,0,0]
  v_pk_fma_f32 v[204:205], v[204:205], v[8:9], v[8:9] op_sel_hi:[1,0,0]
  v_pk_fma_f32 v[206:207], v[206:207], v[8:9], v[8:9] op_sel_hi:[1,0,0]
  v_rcp_f32 v192, v192
  v_rcp_f32 v193, v193
  v_rcp_f32 v194, v194
  v_rcp_f32 v195, v195
  v_rcp_f32 v196, v196
  v_rcp_f32 v197, v197
  v_rcp_f32 v198, v198
  v_rcp_f32 v199, v199
  v_rcp_f32 v200, v200
  v_rcp_f32 v201, v201
  v_rcp_f32 v202, v202
  v_rcp_f32 v203, v203
  v_rcp_f32 v204, v204
  v_rcp_f32 v205, v205
  v_rcp_f32 v206, v206
  v_rcp_f32 v207, v207
  v_pk_mul_f32 v[144:145], v[144:145], v[192:193]
  v_pk_mul_f32 v[146:147], v[146:147], v[194:195]
  v_pk_mul_f32 v[148:149], v[148:149], v[196:197]
  v_pk_mul_f32 v[150:151], v[150:151], v[198:199]
  v_pk_mul_f32 v[152:153], v[152:153], v[200:201]
  v_pk_mul_f32 v[154:155], v[154:155], v[202:203]
  v_pk_mul_f32 v[156:157], v[156:157], v[204:205]
  v_pk_mul_f32 v[158:159], v[158:159], v[206:207]
  v_cvt_pk_bf16_f32 v144, v144, v145
  v_cvt_pk_bf16_f32 v145, v146, v147
  v_cvt_pk_bf16_f32 v146, v148, v149
  v_cvt_pk_bf16_f32 v147, v150, v151
  v_cvt_pk_bf16_f32 v148, v152, v153
  v_cvt_pk_bf16_f32 v149, v154, v155
  v_cvt_pk_bf16_f32 v150, v156, v157
  v_cvt_pk_bf16_f32 v151, v158, v159
  buffer_store_dwordx4 v[144:147], v41, s[12:15], s71 offen sc1
  buffer_store_dwordx4 v[148:151], v41, s[12:15], s71 offen offset:1024 sc1
  s_add_u32 s71, s71, 4096
  s_mov_b32 s59, 1015808
  s_add_u32 m0, s52, 77824
  s_nop 0
  buffer_load_dwordx4 v31, s[16:19], s59 offen lds
  s_cmp_ge_u32 s39, 3
  s_cselect_b32 s53, s42, 0
  s_cmp_eq_u32 s53, 1
  s_cbranch_scc1 L_noT_24
  s_nop 0
  v_pk_mul_f32 v[192:193], v[160:161], v[2:3] op_sel_hi:[1,0]
  v_pk_mul_f32 v[194:195], v[162:163], v[2:3] op_sel_hi:[1,0]
  v_pk_mul_f32 v[196:197], v[164:165], v[2:3] op_sel_hi:[1,0]
  v_pk_mul_f32 v[198:199], v[166:167], v[2:3] op_sel_hi:[1,0]
  v_pk_mul_f32 v[200:201], v[168:169], v[2:3] op_sel_hi:[1,0]
  v_pk_mul_f32 v[202:203], v[170:171], v[2:3] op_sel_hi:[1,0]
  v_pk_mul_f32 v[204:205], v[172:173], v[2:3] op_sel_hi:[1,0]
  v_pk_mul_f32 v[206:207], v[174:175], v[2:3] op_sel_hi:[1,0]
  v_exp_f32 v192, v192
  v_exp_f32 v193, v193
  v_exp_f32 v194, v194
  v_exp_f32 v195, v195
  v_exp_f32 v196, v196
  v_exp_f32 v197, v197
  v_exp_f32 v198, v198
  v_exp_f32 v199, v199
  v_exp_f32 v200, v200
  v_exp_f32 v201, v201
  v_exp_f32 v202, v202
  v_exp_f32 v203, v203
  v_exp_f32 v204, v204
  v_exp_f32 v205, v205
  v_exp_f32 v206, v206
  v_exp_f32 v207, v207
  v_pk_fma_f32 v[192:193], v[192:193], v[6:7], v[6:7] op_sel_hi:[1,0,0]
  v_pk_fma_f32 v[194:195], v[194:195], v[6:7], v[6:7] op_sel_hi:[1,0,0]
  v_pk_fma_f32 v[196:197], v[196:197], v[6:7], v[6:7] op_sel_hi:[1,0,0]
  v_pk_fma_f32 v[198:199], v[198:199], v[6:7], v[6:7] op_sel_hi:[1,0,0]
  v_pk_fma_f32 v[200:201], v[200:201], v[6:7], v[6:7] op_sel_hi:[1,0,0]
  v_pk_fma_f32 v[202:203], v[202:203], v[6:7], v[6:7] op_sel_hi:[1,0,0]
  v_pk_fma_f32 v[204:205], v[204:205], v[6:7], v[6:7] op_sel_hi:[1,0,0]
  v_pk_fma_f32 v[206:207], v[206:207], v[6:7], v[6:7] op_sel_hi:[1,0,0]
  v_rcp_f32 v192, v192
  v_rcp_f32 v193, v193
  v_rcp_f32 v194, v194
  v_rcp_f32 v195, v195
  v_rcp_f32 v196, v196
  v_rcp_f32 v197, v197
  v_rcp_f32 v198, v198
  v_rcp_f32 v199, v199
  v_rcp_f32 v200, v200
  v_rcp_f32 v201, v201
  v_rcp_f32 v202, v202
  v_rcp_f32 v203, v203
  v_rcp_f32 v204, v204
  v_rcp_f32 v205, v205
  v_rcp_f32 v206, v206
  v_rcp_f32 v207, v207
  v_pk_mul_f32 v[160:161], v[160:161], v[192:193]
  v_pk_mul_f32 v[162:163], v[162:163], v[194:195]
  v_pk_mul_f32 v[164:165], v[164:165], v[196:197]
  v_pk_mul_f32 v[166:167], v[166:167], v[198:199]
  v_pk_mul_f32 v[168:169], v[168:169], v[200:201]
  v_pk_mul_f32 v[170:171], v[170:171], v[202:203]
  v_pk_mul_f32 v[172:173], v[172:173], v[204:205]
  v_pk_mul_f32 v[174:175], v[174:175], v[206:207]
  v_cvt_pk_bf16_f32 v160, v160, v161
  v_cvt_pk_bf16_f32 v161, v162, v163
  v_cvt_pk_bf16_f32 v162, v164, v165
  v_cvt_pk_bf16_f32 v163, v166, v167
  v_cvt_pk_bf16_f32 v164, v168, v169
  v_cvt_pk_bf16_f32 v165, v170, v171
  v_cvt_pk_bf16_f32 v166, v172, v173
  v_cvt_pk_bf16_f32 v167, v174, v175
  buffer_store_dwordx4 v[160:163], v41, s[12:15], s70 offen sc1
  buffer_store_dwordx4 v[164:167], v41, s[12:15], s70 offen offset:1024 sc1
  s_add_u32 s70, s70, 4096
  v_pk_mul_f32 v[192:193], v[176:177], v[4:5] op_sel_hi:[1,0]
  v_pk_mul_f32 v[194:195], v[178:179], v[4:5] op_sel_hi:[1,0]
  v_pk_mul_f32 v[196:197], v[180:181], v[4:5] op_sel_hi:[1,0]
  v_pk_mul_f32 v[198:199], v[182:183], v[4:5] op_sel_hi:[1,0]
  v_pk_mul_f32 v[200:201], v[184:185], v[4:5] op_sel_hi:[1,0]
  v_pk_mul_f32 v[202:203], v[186:187], v[4:5] op_sel_hi:[1,0]
  v_pk_mul_f32 v[204:205], v[188:189], v[4:5] op_sel_hi:[1,0]
  v_pk_mul_f32 v[206:207], v[190:191], v[4:5] op_sel_hi:[1,0]
  v_exp_f32 v192, v192
  v_exp_f32 v193, v193
  v_exp_f32 v194, v194
  v_exp_f32 v195, v195
  v_exp_f32 v196, v196
  v_exp_f32 v197, v197
  v_exp_f32 v198, v198
  v_exp_f32 v199, v199
  v_exp_f32 v200, v200
  v_exp_f32 v201, v201
  v_exp_f32 v202, v202
  v_exp_f32 v203, v203
  v_exp_f32 v204, v204
  v_exp_f32 v205, v205
  v_exp_f32 v206, v206
  v_exp_f32 v207, v207
  v_pk_fma_f32 v[192:193], v[192:193], v[8:9], v[8:9] op_sel_hi:[1,0,0]
  v_pk_fma_f32 v[194:195], v[194:195], v[8:9], v[8:9] op_sel_hi:[1,0,0]
  v_pk_fma_f32 v[196:197], v[196:197], v[8:9], v[8:9] op_sel_hi:[1,0,0]
  v_pk_fma_f32 v[198:199], v[198:199], v[8:9], v[8:9] op_sel_hi:[1,0,0]
  v_pk_fma_f32 v[200:201], v[200:201], v[8:9], v[8:9] op_sel_hi:[1,0,0]
  v_pk_fma_f32 v[202:203], v[202:203], v[8:9], v[8:9] op_sel_hi:[1,0,0]
  v_pk_fma_f32 v[204:205], v[204:205], v[8:9], v[8:9] op_sel_hi:[1,0,0]
  v_pk_fma_f32 v[206:207], v[206:207], v[8:9], v[8:9] op_sel_hi:[1,0,0]
  v_rcp_f32 v192, v192
  v_rcp_f32 v193, v193
  v_rcp_f32 v194, v194
  v_rcp_f32 v195, v195
  v_rcp_f32 v196, v196
  v_rcp_f32 v197, v197
  v_rcp_f32 v198, v198
  v_rcp_f32 v199, v199
  v_rcp_f32 v200, v200
  v_rcp_f32 v201, v201
  v_rcp_f32 v202, v202
  v_rcp_f32 v203, v203
  v_rcp_f32 v204, v204
  v_rcp_f32 v205, v205
  v_rcp_f32 v206, v206
  v_rcp_f32 v207, v207
  v_pk_mul_f32 v[176:177], v[176:177], v[192:193]
  v_pk_mul_f32 v[178:179], v[178:179], v[194:195]
  v_pk_mul_f32 v[180:181], v[180:181], v[196:197]
  v_pk_mul_f32 v[182:183], v[182:183], v[198:199]
  v_pk_mul_f32 v[184:185], v[184:185], v[200:201]
  v_pk_mul_f32 v[186:187], v[186:187], v[202:203]
  v_pk_mul_f32 v[188:189], v[188:189], v[204:205]
  v_pk_mul_f32 v[190:191], v[190:191], v[206:207]
  v_cvt_pk_bf16_f32 v176, v176, v177
  v_cvt_pk_bf16_f32 v177, v178, v179
  v_cvt_pk_bf16_f32 v178, v180, v181
  v_cvt_pk_bf16_f32 v179, v182, v183
  v_cvt_pk_bf16_f32 v180, v184, v185
  v_cvt_pk_bf16_f32 v181, v186, v187
  v_cvt_pk_bf16_f32 v182, v188, v189
  v_cvt_pk_bf16_f32 v183, v190, v191
  buffer_store_dwordx4 v[176:179], v41, s[12:15], s71 offen sc1
  buffer_store_dwordx4 v[180:183], v41, s[12:15], s71 offen offset:1024 sc1
  s_add_u32 s71, s71, 4096
L_noT_24:
  v_and_b32 v2, 31, v1
  v_lshrrev_b32 v3, 5, v1
  s_lshl_b32 s53, s92, 5
  v_add_u32 v2, s53, v2
  v_lshlrev_b32_e64 v2, 10, v2
  v_lshl_or_b32 v2, v3, 5, v2
  s_lshl_b32 s53, s39, 7
  s_lshl_b32 s54, s42, 6
  s_add_u32 s53, s53, s54
  v_add_u32 v168, s53, v2
  buffer_load_dwordx4 v[160:163], v168, s[4:7], 0 offen
  buffer_load_dwordx4 v[164:167], v168, s[4:7], 0 offen offset:16
  v_bfe_u32 v2, v1, 2, 1
  v_lshrrev_b32_e64 v3, 5, v1
  v_bfe_u32 v4, v1, 3, 2
  v_and_b32_e64 v5, 3, v1
  v_lshl_add_u32 v4, v4, 2, v5
  s_lshl_b32 s53, s42, 1
  v_add_u32 v6, s53, v3
  v_mul_u32_u24 v6, 17, v6
  v_add_u32 v7, v6, v4
  v_mov_b32 v8, 68
  v_cmp_eq_u32 vcc, v2, v3
  s_nop 1
  v_cndmask_b32 v7, v8, v7, vcc
  v_mul_u32_u24 v7, 80, v7
  v_add_u32 v170, 131072, v7
  v_add_u32 v7, 16, v6
  v_cndmask_b32 v7, v8, v7, vcc
  v_cmp_eq_u32 vcc, 0, v4
  s_nop 1
  v_cndmask_b32 v7, v8, v7, vcc
  v_mul_u32_u24 v7, 80, v7
  v_add_u32 v171, 131072, v7
  v_lshlrev_b32 v172, 4, v0
  v_lshrrev_b32 v2, 3, v0
  v_mul_u32_u24 v2, 80, v2
  v_and_b32_e64 v3, 7, v0
  v_lshl_add_u32 v2, v3, 3, v2
  v_add_u32 v173, 131072, v2
  s_lshl_b32 s55, s37, 7
  s_lshl_b32 s53, s39, 2
  s_add_u32 s55, s55, s53
  s_add_u32 s55, s55, 8192
  s_cmp_eq_u32 s36, 0
  s_cbranch_scc0 L_pi_25
  v_mov_b32_e64 v12, s55
  s_mov_b64 exec, 1
  buffer_load_dword v13, v12, s[12:15], 0 offen sc1
  s_mov_b64 exec, -1
L_pi_25:
  s_waitcnt vmcnt(2)
  s_barrier
  s_lshl_b32 s53, s37, 8
  s_add_u32 s53, s53, 4096
  s_add_u32 s54, s53, 128
  s_cmp_eq_u32 s36, 0
  s_cbranch_scc0 L_sg_26
  v_mov_b32 v14, s53
  v_mov_b32 v15, 1
  v_writelane_b32 v14, s54, 1
  s_mov_b64 exec, 3
  buffer_atomic_add v15, v14, s[12:15], 0 offen sc1
  s_mov_b64 exec, -1
L_sg_26:
  ds_read_b64_tr_b16 a[64:65], v39 offset:57344
  ds_read_b64_tr_b16 a[66:67], v39 offset:57856
  ds_read_b64_tr_b16 a[68:69], v39 offset:57600
  ds_read_b64_tr_b16 a[70:71], v39 offset:58112
  ds_read_b64_tr_b16 a[72:73], v39 offset:61440
  ds_read_b64_tr_b16 a[74:75], v39 offset:61952
  ds_read_b64_tr_b16 a[76:77], v39 offset:61696
  ds_read_b64_tr_b16 a[78:79], v39 offset:62208
  ds_read_b64_tr_b16 a[80:81], v39 offset:16384
  ds_read_b64_tr_b16 a[82:83], v39 offset:16896
  ds_read_b64_tr_b16 a[84:85], v39 offset:16640
  ds_read_b64_tr_b16 a[86:87], v39 offset:17152
  ds_read_b64_tr_b16 a[88:89], v39 offset:20480
  ds_read_b64_tr_b16 a[90:91], v39 offset:20992
  ds_read_b64_tr_b16 a[92:93], v39 offset:20736
  ds_read_b64_tr_b16 a[94:95], v39 offset:21248
  ds_read_b64_tr_b16 a[96:97], v39 offset:24576
  ds_read_b64_tr_b16 a[98:99], v39 offset:25088
  ds_read_b64_tr_b16 a[100:101], v39 offset:24832
  ds_read_b64_tr_b16 a[102:103], v39 offset:25344
  ds_read_b64_tr_b16 a[104:105], v39 offset:28672
  ds_read_b64_tr_b16 a[106:107], v39 offset:29184
  ds_read_b64_tr_b16 a[108:109], v39 offset:28928
  ds_read_b64_tr_b16 a[110:111], v39 offset:29440
  ds_read_b64_tr_b16 a[112:113], v39 offset:32768
  ds_read_b64_tr_b16 a[114:115], v39 offset:33280
  ds_read_b64_tr_b16 a[116:117], v39 offset:33024
  ds_read_b64_tr_b16 a[118:119], v39 offset:33536
  ds_read_b64_tr_b16 a[120:121], v39 offset:36864
  ds_read_b64_tr_b16 a[122:123], v39 offset:37376
  ds_read_b64_tr_b16 a[124:125], v39 offset:37120
  ds_read_b64_tr_b16 a[126:127], v39 offset:37632
  ds_read_b64_tr_b16 a[128:129], v39 offset:40960
  ds_read_b64_tr_b16 a[130:131], v39 offset:41472
  ds_read_b64_tr_b16 a[132:133], v39 offset:41216
  ds_read_b64_tr_b16 a[134:135], v39 offset:41728
  ds_read_b64_tr_b16 a[136:137], v39 offset:45056
  ds_read_b64_tr_b16 a[138:139], v39 offset:45568
  ds_read_b64_tr_b16 a[140:141], v39 offset:45312
  ds_read_b64_tr_b16 a[142:143], v39 offset:45824
  ds_read_b64_tr_b16 a[144:145], v39 offset:49152
  ds_read_b64_tr_b16 a[146:147], v39 offset:49664
  ds_read_b64_tr_b16 a[148:149], v39 offset:49408
  ds_read_b64_tr_b16 a[150:151], v39 offset:49920
  ds_read_b64_tr_b16 a[152:153], v39 offset:53248
  ds_read_b64_tr_b16 a[154:155], v39 offset:53760
  ds_read_b64_tr_b16 a[156:157], v39 offset:53504
  ds_read_b64_tr_b16 a[158:159], v39 offset:54016
  ds_read_b64_tr_b16 a[160:161], v38 offset:0
  ds_read_b64_tr_b16 a[162:163], v38 offset:512
  ds_read_b64_tr_b16 a[164:165], v38 offset:256
  ds_read_b64_tr_b16 a[166:167], v38 offset:768
  ds_read_b64_tr_b16 a[168:169], v38 offset:4096
  ds_read_b64_tr_b16 a[170:171], v38 offset:4608
  ds_read_b64_tr_b16 a[172:173], v38 offset:4352
  ds_read_b64_tr_b16 a[174:175], v38 offset:4864
  ds_read_b64_tr_b16 a[176:177], v38 offset:8192
  ds_read_b64_tr_b16 a[178:179], v38 offset:8704
  ds_read_b64_tr_b16 a[180:181], v38 offset:8448
  ds_read_b64_tr_b16 a[182:183], v38 offset:8960
  ds_read_b64_tr_b16 a[184:185], v38 offset:12288
  ds_read_b64_tr_b16 a[186:187], v38 offset:12800
  ds_read_b64_tr_b16 a[188:189], v38 offset:12544
  ds_read_b64_tr_b16 a[190:191], v38 offset:13056
  s_waitcnt lgkmcnt(0)
  s_cmp_eq_u32 s36, 0
  s_cbranch_scc0 L_pc_27
  s_waitcnt vmcnt(0)
  s_mov_b64 exec, 1
  v_cmp_ne_u32 vcc, 2, v13
  s_cbranch_vccz L_cqd_29
  s_mov_b32 s60, 0
L_cq_28:
  buffer_load_dword v13, v12, s[12:15], 0 offen sc1
  s_add_u32 s60, s60, 1
  s_waitcnt vmcnt(0)
  v_cmp_ne_u32 vcc, 2, v13
  s_cmp_gt_u32 s60, 0x20000
  s_cbranch_scc1 L_cqd_29
  s_cbranch_vccnz L_cq_28
L_cqd_29:
  s_mov_b64 exec, -1
L_pc_27:
  s_barrier
  s_lshl_b32 s53, s92, 4
  s_add_u32 s53, s53, s93
  s_lshl_b32 s53, s53, 11
  s_add_u32 s53, s53, 1048576
  buffer_load_dwordx4 v[180:183], v41, s[12:15], s53 offen sc1
  buffer_load_dwordx4 v[184:187], v41, s[12:15], s53 offen offset:1024 sc1
  s_mov_b32 s59, 1048576
  s_add_u32 m0, s52, 122880
  s_nop 0
  buffer_load_dwordx4 v31, s[16:19], s59 offen lds
  s_mov_b32 s59, 1081344
  s_add_u32 m0, s52, 126976
  s_nop 0
  buffer_load_dwordx4 v31, s[16:19], s59 offen lds
  s_mov_b32 s59, 1114112
  s_add_u32 m0, s52, 81920
  s_nop 0
  buffer_load_dwordx4 v31, s[16:19], s59 offen lds
  s_mov_b32 s59, 1146880
  s_add_u32 m0, s52, 86016
  s_nop 0
  buffer_load_dwordx4 v31, s[16:19], s59 offen lds
  s_mov_b32 s59, 1179648
  s_add_u32 m0, s52, 90112
  s_nop 0
  buffer_load_dwordx4 v31, s[16:19], s59 offen lds
  s_mov_b32 s59, 1212416
  s_add_u32 m0, s52, 94208
  s_nop 0
  buffer_load_dwordx4 v31, s[16:19], s59 offen lds
  s_mov_b32 s59, 1245184
  s_add_u32 m0, s52, 98304
  s_nop 0
  buffer_load_dwordx4 v31, s[16:19], s59 offen lds
  s_mov_b32 s59, 1277952
  s_add_u32 m0, s52, 102400
  s_nop 0
  buffer_load_dwordx4 v31, s[16:19], s59 offen lds
  s_lshl_b32 s55, s45, 7
  s_add_u32 s55, s55, 4096
  s_cmp_eq_u32 s36, 0
  s_cbranch_scc0 L_pi_30
  v_mov_b32_e64 v12, s55
  s_mov_b64 exec, 1
  buffer_load_dword v13, v12, s[12:15], 0 offen sc1
  s_mov_b64 exec, -1
L_pi_30:
  s_branch L_p2
L_att:
  v_pk_mul_f32 v[96:97], v[96:97], v[44:45] op_sel_hi:[1,0]
  v_pk_mul_f32 v[98:99], v[98:99], v[44:45] op_sel_hi:[1,0]
  v_pk_mul_f32 v[100:101], v[100:101], v[44:45] op_sel_hi:[1,0]
  v_pk_mul_f32 v[102:103], v[102:103], v[44:45] op_sel_hi:[1,0]
  v_pk_mul_f32 v[104:105], v[104:105], v[44:45] op_sel_hi:[1,0]
  v_pk_mul_f32 v[106:107], v[106:107], v[44:45] op_sel_hi:[1,0]
  v_pk_mul_f32 v[108:109], v[108:109], v[44:45] op_sel_hi:[1,0]
  v_pk_mul_f32 v[110:111], v[110:111], v[44:45] op_sel_hi:[1,0]
  v_cvt_pk_bf16_f32 v96, v96, v97
  v_cvt_pk_bf16_f32 v97, v98, v99
  v_cvt_pk_bf16_f32 v98, v100, v101
  v_cvt_pk_bf16_f32 v99, v102, v103
  v_cvt_pk_bf16_f32 v100, v104, v105
  v_cvt_pk_bf16_f32 v101, v106, v107
  v_cvt_pk_bf16_f32 v102, v108, v109
  v_cvt_pk_bf16_f32 v103, v110, v111
  v_pk_mul_f32 v[112:113], v[112:113], v[46:47] op_sel_hi:[1,0]
  v_pk_mul_f32 v[114:115], v[114:115], v[46:47] op_sel_hi:[1,0]
  v_pk_mul_f32 v[116:117], v[116:117], v[46:47] op_sel_hi:[1,0]
  v_pk_mul_f32 v[118:119], v[118:119], v[46:47] op_sel_hi:[1,0]
  v_pk_mul_f32 v[120:121], v[120:121], v[46:47] op_sel_hi:[1,0]
  v_pk_mul_f32 v[122:123], v[122:123], v[46:47] op_sel_hi:[1,0]
  v_pk_mul_f32 v[124:125], v[124:125], v[46:47] op_sel_hi:[1,0]
  v_pk_mul_f32 v[126:127], v[126:127], v[46:47] op_sel_hi:[1,0]
  v_cvt_pk_bf16_f32 v112, v112, v113
  v_cvt_pk_bf16_f32 v113, v114, v115
  v_cvt_pk_bf16_f32 v114, v116, v117
  v_cvt_pk_bf16_f32 v115, v118, v119
  v_cvt_pk_bf16_f32 v116, v120, v121
  v_cvt_pk_bf16_f32 v117, v122, v123
  v_cvt_pk_bf16_f32 v118, v124, v125
  v_cvt_pk_bf16_f32 v119, v126, v127
  s_cmp_eq_u32 s41, 0
  s_cbranch_scc1 L_q0_31
  s_lshl_b32 s53, s37, 2
  s_add_u32 s53, s53, 2
  s_lshl_b32 s53, s53, 4
  s_add_u32 s53, s53, s93
  s_lshl_b32 s53, s53, 11
  s_add_u32 s53, s53, 1048576
  buffer_store_dwordx4 v[96:99], v41, s[12:15], s53 offen sc1
  buffer_store_dwordx4 v[100:103], v41, s[12:15], s53 offen offset:1024 sc1
  s_lshl_b32 s53, s37, 2
  s_add_u32 s53, s53, 3
  s_lshl_b32 s53, s53, 4
  s_add_u32 s53, s53, s93
  s_lshl_b32 s53, s53, 11
  s_add_u32 s53, s53, 1048576
  buffer_store_dwordx4 v[112:115], v41, s[12:15], s53 offen sc1
  buffer_store_dwordx4 v[116:119], v41, s[12:15], s53 offen offset:1024 sc1
  s_branch L_q1_32
L_q0_31:
  s_lshl_b32 s53, s42, 11
  s_add_u32 s53, s53, 155648
  v_add_u32_e64 v2, s53, v41
  ds_write_b128 v2, v[112:115]
  ds_write_b128 v2, v[116:119] offset:1024
L_q1_32:
  s_mov_b32 s59, 720896
  s_add_u32 m0, s52, 40960
  s_nop 0
  buffer_load_dwordx4 v31, s[16:19], s59 offen lds
  s_mov_b32 s59, 753664
  s_add_u32 m0, s52, 45056
  s_nop 0
  buffer_load_dwordx4 v31, s[16:19], s59 offen lds
  v_pk_mul_f32 v[128:129], v[128:129], v[44:45] op_sel_hi:[1,0]
  v_pk_mul_f32 v[130:131], v[130:131], v[44:45] op_sel_hi:[1,0]
  v_pk_mul_f32 v[132:133], v[132:133], v[44:45] op_sel_hi:[1,0]
  v_pk_mul_f32 v[134:135], v[134:135], v[44:45] op_sel_hi:[1,0]
  v_pk_mul_f32 v[136:137], v[136:137], v[44:45] op_sel_hi:[1,0]
  v_pk_mul_f32 v[138:139], v[138:139], v[44:45] op_sel_hi:[1,0]
  v_pk_mul_f32 v[140:141], v[140:141], v[44:45] op_sel_hi:[1,0]
  v_pk_mul_f32 v[142:143], v[142:143], v[44:45] op_sel_hi:[1,0]
  v_cvt_pk_bf16_f32 v128, v128, v129
  v_cvt_pk_bf16_f32 v129, v130, v131
  v_cvt_pk_bf16_f32 v130, v132, v133
  v_cvt_pk_bf16_f32 v131, v134, v135
  v_cvt_pk_bf16_f32 v132, v136, v137
  v_cvt_pk_bf16_f32 v133, v138, v139
  v_cvt_pk_bf16_f32 v134, v140, v141
  v_cvt_pk_bf16_f32 v135, v142, v143
  v_mfma_f32_32x32x16_bf16 v[192:207], v[16:19], v[128:131], 0
  s_nop 0
  v_mfma_f32_32x32x16_bf16 v[192:207], v[20:23], v[132:135], v[192:207]
  v_pk_mul_f32 v[144:145], v[144:145], v[46:47] op_sel_hi:[1,0]
  v_pk_mul_f32 v[146:147], v[146:147], v[46:47] op_sel_hi:[1,0]
  v_pk_mul_f32 v[148:149], v[148:149], v[46:47] op_sel_hi:[1,0]
  v_pk_mul_f32 v[150:151], v[150:151], v[46:47] op_sel_hi:[1,0]
  v_pk_mul_f32 v[152:153], v[152:153], v[46:47] op_sel_hi:[1,0]
  v_pk_mul_f32 v[154:155], v[154:155], v[46:47] op_sel_hi:[1,0]
  v_pk_mul_f32 v[156:157], v[156:157], v[46:47] op_sel_hi:[1,0]
  v_pk_mul_f32 v[158:159], v[158:159], v[46:47] op_sel_hi:[1,0]
  v_cvt_pk_bf16_f32 v144, v144, v145
  v_cvt_pk_bf16_f32 v145, v146, v147
  v_cvt_pk_bf16_f32 v146, v148, v149
  v_cvt_pk_bf16_f32 v147, v150, v151
  v_cvt_pk_bf16_f32 v148, v152, v153
  v_cvt_pk_bf16_f32 v149, v154, v155
  v_cvt_pk_bf16_f32 v150, v156, v157
  v_cvt_pk_bf16_f32 v151, v158, v159
  v_mfma_f32_32x32x16_bf16 v[208:223], v[16:19], v[144:147], 0
  s_nop 0
  v_mfma_f32_32x32x16_bf16 v[208:223], v[20:23], v[148:151], v[208:223]
  v_pk_mul_f32 v[160:161], v[160:161], v[44:45] op_sel_hi:[1,0]
  v_pk_mul_f32 v[162:163], v[162:163], v[44:45] op_sel_hi:[1,0]
  v_pk_mul_f32 v[164:165], v[164:165], v[44:45] op_sel_hi:[1,0]
  v_pk_mul_f32 v[166:167], v[166:167], v[44:45] op_sel_hi:[1,0]
  v_pk_mul_f32 v[168:169], v[168:169], v[44:45] op_sel_hi:[1,0]
  v_pk_mul_f32 v[170:171], v[170:171], v[44:45] op_sel_hi:[1,0]
  v_pk_mul_f32 v[172:173], v[172:173], v[44:45] op_sel_hi:[1,0]
  v_pk_mul_f32 v[174:175], v[174:175], v[44:45] op_sel_hi:[1,0]
  v_cvt_pk_bf16_f32 v160, v160, v161
  v_cvt_pk_bf16_f32 v161, v162, v163
  v_cvt_pk_bf16_f32 v162, v164, v165
  v_cvt_pk_bf16_f32 v163, v166, v167
  v_cvt_pk_bf16_f32 v164, v168, v169
  v_cvt_pk_bf16_f32 v165, v170, v171
  v_cvt_pk_bf16_f32 v166, v172, v173
  v_cvt_pk_bf16_f32 v167, v174, v175
  v_pk_mul_f32 v[176:177], v[176:177], v[46:47] op_sel_hi:[1,0]
  v_pk_mul_f32 v[178:179], v[178:179], v[46:47] op_sel_hi:[1,0]
  v_pk_mul_f32 v[180:181], v[180:181], v[46:47] op_sel_hi:[1,0]
  v_pk_mul_f32 v[182:183], v[182:183], v[46:47] op_sel_hi:[1,0]
  v_pk_mul_f32 v[184:185], v[184:185], v[46:47] op_sel_hi:[1,0]
  v_pk_mul_f32 v[186:187], v[186:187], v[46:47] op_sel_hi:[1,0]
  v_pk_mul_f32 v[188:189], v[188:189], v[46:47] op_sel_hi:[1,0]
  v_pk_mul_f32 v[190:191], v[190:191], v[46:47] op_sel_hi:[1,0]
  v_cvt_pk_bf16_f32 v176, v176, v177
  v_cvt_pk_bf16_f32 v177, v178, v179
  v_cvt_pk_bf16_f32 v178, v180, v181
  v_cvt_pk_bf16_f32 v179, v182, v183
  v_cvt_pk_bf16_f32 v180, v184, v185
  v_cvt_pk_bf16_f32 v181, v186, v187
  v_cvt_pk_bf16_f32 v182, v188, v189
  v_cvt_pk_bf16_f32 v183, v190, v191
  s_mov_b32 s59, 786432
  s_add_u32 m0, s52, 49152
  s_nop 0
  buffer_load_dwordx4 v31, s[16:19], s59 offen lds
  s_mov_b32 s59, 819200
  s_add_u32 m0, s52, 53248
  s_nop 0
  buffer_load_dwordx4 v31, s[16:19], s59 offen lds
  v_max3_f32 v2, v192, v193, v194
  v_min3_f32 v3, v192, v193, v194
  v_max3_f32 v2, v2, v195, v196
  v_min3_f32 v3, v3, v195, v196
  v_max3_f32 v2, v2, v197, v198
  v_min3_f32 v3, v3, v197, v198
  v_max3_f32 v2, v2, v199, v200
  v_min3_f32 v3, v3, v199, v200
  v_max3_f32 v2, v2, v201, v202
  v_min3_f32 v3, v3, v201, v202
  v_max3_f32 v2, v2, v203, v204
  v_min3_f32 v3, v3, v203, v204
  v_max3_f32 v2, v2, v205, v206
  v_min3_f32 v3, v3, v205, v206
  v_max_f32 v2, v2, v207
  v_min_f32 v3, v3, v207
  v_mul_f32 v4, 0xbfb8aa3b, v2
  v_mul_f32 v6, 0x3fb8aa3b, v3
  v_pk_fma_f32 v[224:225], v[192:193], s[64:65], v[4:5] op_sel_hi:[1,1,0]
  v_pk_fma_f32 v[226:227], v[194:195], s[64:65], v[4:5] op_sel_hi:[1,1,0]
  v_pk_fma_f32 v[228:229], v[196:197], s[64:65], v[4:5] op_sel_hi:[1,1,0]
  v_pk_fma_f32 v[230:231], v[198:199], s[64:65], v[4:5] op_sel_hi:[1,1,0]
  v_pk_fma_f32 v[232:233], v[200:201], s[64:65], v[4:5] op_sel_hi:[1,1,0]
  v_pk_fma_f32 v[234:235], v[202:203], s[64:65], v[4:5] op_sel_hi:[1,1,0]
  v_pk_fma_f32 v[236:237], v[204:205], s[64:65], v[4:5] op_sel_hi:[1,1,0]
  v_pk_fma_f32 v[238:239], v[206:207], s[64:65], v[4:5] op_sel_hi:[1,1,0]
  v_pk_fma_f32 v[192:193], v[192:193], s[64:65], v[6:7] op_sel_hi:[1,1,0] neg_lo:[1,0,0] neg_hi:[1,0,0]
  v_pk_fma_f32 v[194:195], v[194:195], s[64:65], v[6:7] op_sel_hi:[1,1,0] neg_lo:[1,0,0] neg_hi:[1,0,0]
  v_pk_fma_f32 v[196:197], v[196:197], s[64:65], v[6:7] op_sel_hi:[1,1,0] neg_lo:[1,0,0] neg_hi:[1,0,0]
  v_pk_fma_f32 v[198:199], v[198:199], s[64:65], v[6:7] op_sel_hi:[1,1,0] neg_lo:[1,0,0] neg_hi:[1,0,0]
  v_pk_fma_f32 v[200:201], v[200:201], s[64:65], v[6:7] op_sel_hi:[1,1,0] neg_lo:[1,0,0] neg_hi:[1,0,0]
  v_pk_fma_f32 v[202:203], v[202:203], s[64:65], v[6:7] op_sel_hi:[1,1,0] neg_lo:[1,0,0] neg_hi:[1,0,0]
  v_pk_fma_f32 v[204:205], v[204:205], s[64:65], v[6:7] op_sel_hi:[1,1,0] neg_lo:[1,0,0] neg_hi:[1,0,0]
  v_pk_fma_f32 v[206:207], v[206:207], s[64:65], v[6:7] op_sel_hi:[1,1,0] neg_lo:[1,0,0] neg_hi:[1,0,0]
  v_exp_f32 v224, v224
  v_exp_f32 v225, v225
  v_exp_f32 v226, v226
  v_exp_f32 v227, v227
  v_exp_f32 v228, v228
  v_exp_f32 v229, v229
  v_exp_f32 v230, v230
  v_exp_f32 v231, v231
  v_exp_f32 v232, v232
  v_exp_f32 v233, v233
  v_exp_f32 v234, v234
  v_exp_f32 v235, v235
  v_exp_f32 v236, v236
  v_exp_f32 v237, v237
  v_exp_f32 v238, v238
  v_exp_f32 v239, v239
  v_exp_f32 v192, v192
  v_exp_f32 v193, v193
  v_exp_f32 v194, v194
  v_exp_f32 v195, v195
  v_exp_f32 v196, v196
  v_exp_f32 v197, v197
  v_exp_f32 v198, v198
  v_exp_f32 v199, v199
  v_exp_f32 v200, v200
  v_exp_f32 v201, v201
  v_exp_f32 v202, v202
  v_exp_f32 v203, v203
  v_exp_f32 v204, v204
  v_exp_f32 v205, v205
  v_exp_f32 v206, v206
  v_exp_f32 v207, v207
  v_pk_add_f32 v[8:9], v[224:225], v[226:227]
  v_pk_add_f32 v[10:11], v[192:193], v[194:195]
  v_pk_add_f32 v[8:9], v[8:9], v[228:229]
  v_pk_add_f32 v[10:11], v[10:11], v[196:197]
  v_pk_add_f32 v[8:9], v[8:9], v[230:231]
  v_pk_add_f32 v[10:11], v[10:11], v[198:199]
  v_pk_add_f32 v[8:9], v[8:9], v[232:233]
  v_pk_add_f32 v[10:11], v[10:11], v[200:201]
  v_pk_add_f32 v[8:9], v[8:9], v[234:235]
  v_pk_add_f32 v[10:11], v[10:11], v[202:203]
  v_pk_add_f32 v[8:9], v[8:9], v[236:237]
  v_pk_add_f32 v[10:11], v[10:11], v[204:205]
  v_pk_add_f32 v[8:9], v[8:9], v[238:239]
  v_pk_add_f32 v[10:11], v[10:11], v[206:207]
  v_add_f32 v8, v8, v9
  v_add_f32 v10, v10, v11
  v_rcp_f32 v8, v8
  v_rcp_f32 v10, v10
  v_pk_mul_f32 v[224:225], v[224:225], v[8:9] op_sel_hi:[1,0]
  v_pk_mul_f32 v[226:227], v[226:227], v[8:9] op_sel_hi:[1,0]
  v_pk_mul_f32 v[228:229], v[228:229], v[8:9] op_sel_hi:[1,0]
  v_pk_mul_f32 v[230:231], v[230:231], v[8:9] op_sel_hi:[1,0]
  v_pk_mul_f32 v[232:233], v[232:233], v[8:9] op_sel_hi:[1,0]
  v_pk_mul_f32 v[234:235], v[234:235], v[8:9] op_sel_hi:[1,0]
  v_pk_mul_f32 v[236:237], v[236:237], v[8:9] op_sel_hi:[1,0]
  v_pk_mul_f32 v[238:239], v[238:239], v[8:9] op_sel_hi:[1,0]
  v_pk_mul_f32 v[192:193], v[192:193], v[10:11] op_sel_hi:[1,0]
  v_pk_mul_f32 v[194:195], v[194:195], v[10:11] op_sel_hi:[1,0]
  v_pk_mul_f32 v[196:197], v[196:197], v[10:11] op_sel_hi:[1,0]
  v_pk_mul_f32 v[198:199], v[198:199], v[10:11] op_sel_hi:[1,0]
  v_pk_mul_f32 v[200:201], v[200:201], v[10:11] op_sel_hi:[1,0]
  v_pk_mul_f32 v[202:203], v[202:203], v[10:11] op_sel_hi:[1,0]
  v_pk_mul_f32 v[204:205], v[204:205], v[10:11] op_sel_hi:[1,0]
  v_pk_mul_f32 v[206:207], v[206:207], v[10:11] op_sel_hi:[1,0]
  v_cvt_pk_bf16_f32 v224, v224, v225
  v_cvt_pk_bf16_f32 v225, v226, v227
  v_cvt_pk_bf16_f32 v226, v228, v229
  v_cvt_pk_bf16_f32 v227, v230, v231
  v_cvt_pk_bf16_f32 v228, v232, v233
  v_cvt_pk_bf16_f32 v229, v234, v235
  v_cvt_pk_bf16_f32 v230, v236, v237
  v_cvt_pk_bf16_f32 v231, v238, v239
  v_cvt_pk_bf16_f32 v192, v192, v193
  v_cvt_pk_bf16_f32 v193, v194, v195
  v_cvt_pk_bf16_f32 v194, v196, v197
  v_cvt_pk_bf16_f32 v195, v198, v199
  v_cvt_pk_bf16_f32 v196, v200, v201
  v_cvt_pk_bf16_f32 v197, v202, v203
  v_cvt_pk_bf16_f32 v198, v204, v205
  v_cvt_pk_bf16_f32 v199, v206, v207
  ds_write_b128 v240, v[224:227]
  v_xor_b32_e64 v2, 16, v240
  ds_write_b128 v2, v[228:231]
  v_xor_b32_e64 v2, 32, v240
  ds_write_b128 v2, v[192:195]
  v_xor_b32_e64 v2, 48, v240
  ds_write_b128 v2, v[196:199]
  ds_write_b128 v241, v[160:163]
  v_xor_b32_e64 v2, 16, v241
  ds_write_b128 v2, v[164:167]
  ds_read_b64_tr_b16 v[48:49], v243 offset:0
  ds_read_b64_tr_b16 v[64:65], v242 offset:0
  ds_read_b64_tr_b16 v[50:51], v243 offset:256
  ds_read_b64_tr_b16 v[66:67], v242 offset:512
  ds_read_b64_tr_b16 v[52:53], v243 offset:512
  ds_read_b64_tr_b16 v[68:69], v242 offset:1024
  ds_read_b64_tr_b16 v[54:55], v243 offset:768
  ds_read_b64_tr_b16 v[70:71], v242 offset:1536
  ds_read_b64_tr_b16 v[56:57], v244 offset:0
  ds_read_b64_tr_b16 v[72:73], v242 offset:2048
  ds_read_b64_tr_b16 v[58:59], v244 offset:256
  ds_read_b64_tr_b16 v[74:75], v242 offset:2560
  ds_read_b64_tr_b16 v[60:61], v244 offset:512
  ds_read_b64_tr_b16 v[76:77], v242 offset:3072
  ds_read_b64_tr_b16 v[62:63], v244 offset:768
  ds_read_b64_tr_b16 v[78:79], v242 offset:3584
  s_mov_b32 s59, 851968
  s_add_u32 m0, s52, 57344
  s_nop 0
  buffer_load_dwordx4 v31, s[16:19], s59 offen lds
  s_mov_b32 s59, 884736
  s_add_u32 m0, s52, 61440
  s_nop 0
  buffer_load_dwordx4 v31, s[16:19], s59 offen lds
  s_mov_b32 s59, 917504
  s_add_u32 m0, s52, 65536
  s_nop 0
  s_nop 0
  buffer_load_dwordx4 v31, s[16:19], s59 offen lds
  v_max3_f32 v2, v208, v209, v210
  v_min3_f32 v3, v208, v209, v210
  v_max3_f32 v2, v2, v211, v212
  v_min3_f32 v3, v3, v211, v212
  v_max3_f32 v2, v2, v213, v214
  v_min3_f32 v3, v3, v213, v214
  v_max3_f32 v2, v2, v215, v216
  v_min3_f32 v3, v3, v215, v216
  v_max3_f32 v2, v2, v217, v218
  v_min3_f32 v3, v3, v217, v218
  v_max3_f32 v2, v2, v219, v220
  v_min3_f32 v3, v3, v219, v220
  v_max3_f32 v2, v2, v221, v222
  v_min3_f32 v3, v3, v221, v222
  v_max_f32 v2, v2, v223
  v_min_f32 v3, v3, v223
  v_mul_f32 v4, 0xbfb8aa3b, v2
  v_mul_f32 v6, 0x3fb8aa3b, v3
  v_pk_fma_f32 v[128:129], v[208:209], s[64:65], v[4:5] op_sel_hi:[1,1,0]
  v_pk_fma_f32 v[130:131], v[210:211], s[64:65], v[4:5] op_sel_hi:[1,1,0]
  v_pk_fma_f32 v[132:133], v[212:213], s[64:65], v[4:5] op_sel_hi:[1,1,0]
  v_pk_fma_f32 v[134:135], v[214:215], s[64:65], v[4:5] op_sel_hi:[1,1,0]
  v_pk_fma_f32 v[136:137], v[216:217], s[64:65], v[4:5] op_sel_hi:[1,1,0]
  v_pk_fma_f32 v[138:139], v[218:219], s[64:65], v[4:5] op_sel_hi:[1,1,0]
  v_pk_fma_f32 v[140:141], v[220:221], s[64:65], v[4:5] op_sel_hi:[1,1,0]
  v_pk_fma_f32 v[142:143], v[222:223], s[64:65], v[4:5] op_sel_hi:[1,1,0]
  v_pk_fma_f32 v[208:209], v[208:209], s[64:65], v[6:7] op_sel_hi:[1,1,0] neg_lo:[1,0,0] neg_hi:[1,0,0]
  v_pk_fma_f32 v[210:211], v[210:211], s[64:65], v[6:7] op_sel_hi:[1,1,0] neg_lo:[1,0,0] neg_hi:[1,0,0]
  v_pk_fma_f32 v[212:213], v[212:213], s[64:65], v[6:7] op_sel_hi:[1,1,0] neg_lo:[1,0,0] neg_hi:[1,0,0]
  v_pk_fma_f32 v[214:215], v[214:215], s[64:65], v[6:7] op_sel_hi:[1,1,0] neg_lo:[1,0,0] neg_hi:[1,0,0]
  v_pk_fma_f32 v[216:217], v[216:217], s[64:65], v[6:7] op_sel_hi:[1,1,0] neg_lo:[1,0,0] neg_hi:[1,0,0]
  v_pk_fma_f32 v[218:219], v[218:219], s[64:65], v[6:7] op_sel_hi:[1,1,0] neg_lo:[1,0,0] neg_hi:[1,0,0]
  v_pk_fma_f32 v[220:221], v[220:221], s[64:65], v[6:7] op_sel_hi:[1,1,0] neg_lo:[1,0,0] neg_hi:[1,0,0]
  v_pk_fma_f32 v[222:223], v[222:223], s[64:65], v[6:7] op_sel_hi:[1,1,0] neg_lo:[1,0,0] neg_hi:[1,0,0]
  v_exp_f32 v128, v128
  v_exp_f32 v129, v129
  v_exp_f32 v130, v130
  v_exp_f32 v131, v131
  v_exp_f32 v132, v132
  v_exp_f32 v133, v133
  v_exp_f32 v134, v134
  v_exp_f32 v135, v135
  v_exp_f32 v136, v136
  v_exp_f32 v137, v137
  v_exp_f32 v138, v138
  v_exp_f32 v139, v139
  v_exp_f32 v140, v140
  v_exp_f32 v141, v141
  v_exp_f32 v142, v142
  v_exp_f32 v143, v143
  v_exp_f32 v208, v208
  v_exp_f32 v209, v209
  v_exp_f32 v210, v210
  v_exp_f32 v211, v211
  v_exp_f32 v212, v212
  v_exp_f32 v213, v213
  v_exp_f32 v214, v214
  v_exp_f32 v215, v215
  v_exp_f32 v216, v216
  v_exp_f32 v217, v217
  v_exp_f32 v218, v218
  v_exp_f32 v219, v219
  v_exp_f32 v220, v220
  v_exp_f32 v221, v221
  v_exp_f32 v222, v222
  v_exp_f32 v223, v223
  v_pk_add_f32 v[8:9], v[128:129], v[130:131]
  v_pk_add_f32 v[10:11], v[208:209], v[210:211]
  v_pk_add_f32 v[8:9], v[8:9], v[132:133]
  v_pk_add_f32 v[10:11], v[10:11], v[212:213]
  v_pk_add_f32 v[8:9], v[8:9], v[134:135]
  v_pk_add_f32 v[10:11], v[10:11], v[214:215]
  v_pk_add_f32 v[8:9], v[8:9], v[136:137]
  v_pk_add_f32 v[10:11], v[10:11], v[216:217]
  v_pk_add_f32 v[8:9], v[8:9], v[138:139]
  v_pk_add_f32 v[10:11], v[10:11], v[218:219]
  v_pk_add_f32 v[8:9], v[8:9], v[140:141]
  v_pk_add_f32 v[10:11], v[10:11], v[220:221]
  v_pk_add_f32 v[8:9], v[8:9], v[142:143]
  v_pk_add_f32 v[10:11], v[10:11], v[222:223]
  v_add_f32 v8, v8, v9
  v_add_f32 v10, v10, v11
  v_rcp_f32 v8, v8
  v_rcp_f32 v10, v10
  v_pk_mul_f32 v[128:129], v[128:129], v[8:9] op_sel_hi:[1,0]
  v_pk_mul_f32 v[130:131], v[130:131], v[8:9] op_sel_hi:[1,0]
  v_pk_mul_f32 v[132:133], v[132:133], v[8:9] op_sel_hi:[1,0]
  v_pk_mul_f32 v[134:135], v[134:135], v[8:9] op_sel_hi:[1,0]
  v_pk_mul_f32 v[136:137], v[136:137], v[8:9] op_sel_hi:[1,0]
  v_pk_mul_f32 v[138:139], v[138:139], v[8:9] op_sel_hi:[1,0]
  v_pk_mul_f32 v[140:141], v[140:141], v[8:9] op_sel_hi:[1,0]
  v_pk_mul_f32 v[142:143], v[142:143], v[8:9] op_sel_hi:[1,0]
  v_pk_mul_f32 v[208:209], v[208:209], v[10:11] op_sel_hi:[1,0]
  v_pk_mul_f32 v[210:211], v[210:211], v[10:11] op_sel_hi:[1,0]
  v_pk_mul_f32 v[212:213], v[212:213], v[10:11] op_sel_hi:[1,0]
  v_pk_mul_f32 v[214:215], v[214:215], v[10:11] op_sel_hi:[1,0]
  v_pk_mul_f32 v[216:217], v[216:217], v[10:11] op_sel_hi:[1,0]
  v_pk_mul_f32 v[218:219], v[218:219], v[10:11] op_sel_hi:[1,0]
  v_pk_mul_f32 v[220:221], v[220:221], v[10:11] op_sel_hi:[1,0]
  v_pk_mul_f32 v[222:223], v[222:223], v[10:11] op_sel_hi:[1,0]
  v_cvt_pk_bf16_f32 v128, v128, v129
  v_cvt_pk_bf16_f32 v129, v130, v131
  v_cvt_pk_bf16_f32 v130, v132, v133
  v_cvt_pk_bf16_f32 v131, v134, v135
  v_cvt_pk_bf16_f32 v132, v136, v137
  v_cvt_pk_bf16_f32 v133, v138, v139
  v_cvt_pk_bf16_f32 v134, v140, v141
  v_cvt_pk_bf16_f32 v135, v142, v143
  v_cvt_pk_bf16_f32 v208, v208, v209
  v_cvt_pk_bf16_f32 v209, v210, v211
  v_cvt_pk_bf16_f32 v210, v212, v213
  v_cvt_pk_bf16_f32 v211, v214, v215
  v_cvt_pk_bf16_f32 v212, v216, v217
  v_cvt_pk_bf16_f32 v213, v218, v219
  v_cvt_pk_bf16_f32 v214, v220, v221
  v_cvt_pk_bf16_f32 v215, v222, v223
  s_waitcnt lgkmcnt(0)
  v_mfma_f32_32x32x16_bf16 v[144:159], v[48:51], v[64:67], 0
  v_mfma_f32_32x32x16_bf16 v[80:95], v[56:59], v[72:75], 0
  v_mfma_f32_32x32x16_bf16 v[144:159], v[52:55], v[68:71], v[144:159]
  v_mfma_f32_32x32x16_bf16 v[80:95], v[60:63], v[76:79], v[80:95]
  ds_write_b128 v240, v[128:131]
  v_xor_b32 v2, 16, v240
  ds_write_b128 v2, v[132:135]
  v_xor_b32_e64 v2, 32, v240
  ds_write_b128 v2, v[208:211]
  v_xor_b32_e64 v2, 48, v240
  ds_write_b128 v2, v[212:215]
  ds_write_b128 v241, v[176:179]
  v_xor_b32_e64 v2, 16, v241
  ds_write_b128 v2, v[180:183]
  ds_read_b64_tr_b16 v[48:49], v243 offset:0
  ds_read_b64_tr_b16 v[64:65], v242 offset:0
  ds_read_b64_tr_b16 v[50:51], v243 offset:256
  ds_read_b64_tr_b16 v[66:67], v242 offset:512
  ds_read_b64_tr_b16 v[52:53], v243 offset:512
  ds_read_b64_tr_b16 v[68:69], v242 offset:1024
  ds_read_b64_tr_b16 v[54:55], v243 offset:768
  ds_read_b64_tr_b16 v[70:71], v242 offset:1536
  ds_read_b64_tr_b16 v[56:57], v244 offset:0
  ds_read_b64_tr_b16 v[72:73], v242 offset:2048
  ds_read_b64_tr_b16 v[58:59], v244 offset:256
  ds_read_b64_tr_b16 v[74:75], v242 offset:2560
  ds_read_b64_tr_b16 v[60:61], v244 offset:512
  ds_read_b64_tr_b16 v[76:77], v242 offset:3072
  ds_read_b64_tr_b16 v[62:63], v244 offset:768
  ds_read_b64_tr_b16 v[78:79], v242 offset:3584
  s_cmp_eq_u32 s41, 0
  s_cbranch_scc1 L_sq_33
  s_waitcnt vmcnt(7)
  s_lshl_b32 s53, s37, 7
  s_lshl_b32 s54, s39, 2
  s_add_u32 s53, s53, s54
  s_add_u32 s53, s53, 8192
  v_mov_b32 v14, s53
  v_mov_b32 v15, 1
  s_mov_b64 s[66:67], exec
  s_mov_b64 exec, 1
  buffer_atomic_add v15, v14, s[12:15], 0 offen sc1
  s_mov_b64 exec, s[66:67]
L_sq_33:
  s_waitcnt lgkmcnt(0)
  v_mfma_f32_32x32x16_bf16 v[144:159], v[48:51], v[64:67], v[144:159]
  v_mfma_f32_32x32x16_bf16 v[80:95], v[56:59], v[72:75], v[80:95]
  v_mfma_f32_32x32x16_bf16 v[144:159], v[52:55], v[68:71], v[144:159]
  v_mfma_f32_32x32x16_bf16 v[80:95], v[60:63], v[76:79], v[80:95]
  s_mov_b32 s59, 950272
  s_add_u32 m0, s52, 69632
  s_nop 0
  buffer_load_dwordx4 v31, s[16:19], s59 offen lds
  s_mov_b32 s59, 983040
  s_add_u32 m0, s52, 73728
  s_nop 0
  buffer_load_dwordx4 v31, s[16:19], s59 offen lds
  s_mov_b32 s59, 1015808
  s_add_u32 m0, s52, 77824
  s_nop 0
  buffer_load_dwordx4 v31, s[16:19], s59 offen lds
  s_lshl_b32 s53, s36, 12
  s_add_u32 s53, s53, 131072
  v_add_u32_e64 v2, s53, v41
  s_xor_b32 s54, s36, 2
  s_lshl_b32 s54, s54, 12
  s_add_u32 s54, s54, 131072
  v_add_u32_e64 v3, s54, v41
  s_mul_i32 s55, s93, 2
  s_add_u32 s55, s55, s41
  s_mul_i32 s55, s55, 2176
  s_add_u32 s55, s55, 32768
  v_lshlrev_b32_e64 v4, 2, v1
  s_cmp_eq_u32 s41, 0
  s_cbranch_scc0 L_kvB_34
  ds_write_b128 v2, v[80:83] offset:0
  ds_write_b128 v2, v[84:87] offset:1024
  ds_write_b128 v2, v[88:91] offset:2048
  ds_write_b128 v2, v[92:95] offset:3072
  s_waitcnt lgkmcnt(0)
  s_waitcnt vmcnt(16)
  s_barrier
  ds_read_b128 v[192:195], v3 offset:0
  ds_read_b128 v[196:199], v3 offset:1024
  ds_read_b128 v[200:203], v3 offset:2048
  ds_read_b128 v[204:207], v3 offset:3072
  v_mov_b32 v180, v96
  v_mov_b32 v181, v97
  v_mov_b32 v182, v98
  v_mov_b32 v183, v99
  v_mov_b32 v184, v100
  v_mov_b32 v185, v101
  v_mov_b32 v186, v102
  v_mov_b32 v187, v103
  s_waitcnt lgkmcnt(0)
  v_pk_add_f32 v[144:145], v[144:145], v[192:193]
  v_pk_add_f32 v[146:147], v[146:147], v[194:195]
  v_pk_add_f32 v[148:149], v[148:149], v[196:197]
  v_pk_add_f32 v[150:151], v[150:151], v[198:199]
  v_pk_add_f32 v[152:153], v[152:153], v[200:201]
  v_pk_add_f32 v[154:155], v[154:155], v[202:203]
  v_pk_add_f32 v[156:157], v[156:157], v[204:205]
  v_pk_add_f32 v[158:159], v[158:159], v[206:207]
  v_permlane32_swap_b32 v144, v145
  v_permlane32_swap_b32 v146, v147
  v_permlane32_swap_b32 v148, v149
  v_permlane32_swap_b32 v150, v151
  v_permlane32_swap_b32 v152, v153
  v_permlane32_swap_b32 v154, v155
  v_permlane32_swap_b32 v156, v157
  v_permlane32_swap_b32 v158, v159
  buffer_atomic_add_f32 v144, v4, s[12:15], s55 offen offset:0
  buffer_atomic_add_f32 v146, v4, s[12:15], s55 offen offset:256
  buffer_atomic_add_f32 v148, v4, s[12:15], s55 offen offset:512
  buffer_atomic_add_f32 v150, v4, s[12:15], s55 offen offset:768
  buffer_atomic_add_f32 v152, v4, s[12:15], s55 offen offset:1024
  buffer_atomic_add_f32 v154, v4, s[12:15], s55 offen offset:1280
  buffer_atomic_add_f32 v156, v4, s[12:15], s55 offen offset:1536
  buffer_atomic_add_f32 v158, v4, s[12:15], s55 offen offset:1792
  s_mov_b64 exec, s[68:69]
  buffer_atomic_add_f32 v145, v4, s[12:15], s55 offen offset:2048
  s_mov_b64 exec, -1
  s_branch L_kvE_35
L_kvB_34:
  ds_write_b128 v2, v[144:147] offset:0
  ds_write_b128 v2, v[148:151] offset:1024
  ds_write_b128 v2, v[152:155] offset:2048
  ds_write_b128 v2, v[156:159] offset:3072
  s_waitcnt lgkmcnt(0)
  s_waitcnt vmcnt(16)
  s_barrier
  ds_read_b128 v[192:195], v3 offset:0
  ds_read_b128 v[196:199], v3 offset:1024
  ds_read_b128 v[200:203], v3 offset:2048
  ds_read_b128 v[204:207], v3 offset:3072
  s_lshl_b32 s53, s42, 11
  s_add_u32 s53, s53, 155648
  v_add_u32 v5, s53, v41
  ds_read_b128 v[180:183], v5
  ds_read_b128 v[184:187], v5 offset:1024
  s_waitcnt lgkmcnt(0)
  s_nop 0
  v_pk_add_f32 v[80:81], v[80:81], v[192:193]
  v_pk_add_f32 v[82:83], v[82:83], v[194:195]
  v_pk_add_f32 v[84:85], v[84:85], v[196:197]
  v_pk_add_f32 v[86:87], v[86:87], v[198:199]
  v_pk_add_f32 v[88:89], v[88:89], v[200:201]
  v_pk_add_f32 v[90:91], v[90:91], v[202:203]
  v_pk_add_f32 v[92:93], v[92:93], v[204:205]
  v_pk_add_f32 v[94:95], v[94:95], v[206:207]
  v_permlane32_swap_b32 v80, v81
  v_permlane32_swap_b32 v82, v83
  v_permlane32_swap_b32 v84, v85
  v_permlane32_swap_b32 v86, v87
  v_permlane32_swap_b32 v88, v89
  v_permlane32_swap_b32 v90, v91
  v_permlane32_swap_b32 v92, v93
  v_permlane32_swap_b32 v94, v95
  buffer_atomic_add_f32 v81, v4, s[12:15], s55 offen offset:0
  buffer_atomic_add_f32 v83, v4, s[12:15], s55 offen offset:256
  buffer_atomic_add_f32 v85, v4, s[12:15], s55 offen offset:512
  buffer_atomic_add_f32 v87, v4, s[12:15], s55 offen offset:768
  buffer_atomic_add_f32 v89, v4, s[12:15], s55 offen offset:1024
  buffer_atomic_add_f32 v91, v4, s[12:15], s55 offen offset:1280
  buffer_atomic_add_f32 v93, v4, s[12:15], s55 offen offset:1536
  buffer_atomic_add_f32 v95, v4, s[12:15], s55 offen offset:1792
  s_mov_b64 exec, s[68:69]
  buffer_atomic_add_f32 v80, v4, s[12:15], s55 offen offset:2048
  s_mov_b64 exec, -1
L_kvE_35:
  v_and_b32 v2, 31, v1
  v_lshrrev_b32 v3, 5, v1
  s_lshl_b32 s53, s92, 5
  v_add_u32 v2, s53, v2
  v_lshlrev_b32_e64 v2, 10, v2
  v_lshl_or_b32 v2, v3, 5, v2
  s_lshl_b32 s53, s39, 7
  s_lshl_b32 s54, s42, 6
  s_add_u32 s53, s53, s54
  v_add_u32 v168, s53, v2
  buffer_load_dwordx4 v[160:163], v168, s[4:7], 0 offen
  buffer_load_dwordx4 v[164:167], v168, s[4:7], 0 offen offset:16
  v_bfe_u32 v2, v1, 2, 1
  v_lshrrev_b32_e64 v3, 5, v1
  v_bfe_u32 v4, v1, 3, 2
  v_and_b32_e64 v5, 3, v1
  v_lshl_add_u32 v4, v4, 2, v5
  s_lshl_b32 s53, s42, 1
  v_add_u32 v6, s53, v3
  v_mul_u32_u24 v6, 17, v6
  v_add_u32 v7, v6, v4
  v_mov_b32 v8, 68
  v_cmp_eq_u32 vcc, v2, v3
  s_nop 1
  v_cndmask_b32 v7, v8, v7, vcc
  v_mul_u32_u24 v7, 80, v7
  v_add_u32 v170, 131072, v7
  v_add_u32 v7, 16, v6
  v_cndmask_b32 v7, v8, v7, vcc
  v_cmp_eq_u32 vcc, 0, v4
  s_nop 1
  v_cndmask_b32 v7, v8, v7, vcc
  v_mul_u32_u24 v7, 80, v7
  v_add_u32 v171, 131072, v7
  v_lshlrev_b32 v172, 4, v0
  v_lshrrev_b32 v2, 3, v0
  v_mul_u32_u24 v2, 80, v2
  v_and_b32_e64 v3, 7, v0
  v_lshl_add_u32 v2, v3, 3, v2
  v_add_u32 v173, 131072, v2
  ds_read_b64_tr_b16 a[64:65], v39 offset:57344
  ds_read_b64_tr_b16 a[66:67], v39 offset:57856
  ds_read_b64_tr_b16 a[68:69], v39 offset:57600
  ds_read_b64_tr_b16 a[70:71], v39 offset:58112
  ds_read_b64_tr_b16 a[72:73], v39 offset:61440
  ds_read_b64_tr_b16 a[74:75], v39 offset:61952
  ds_read_b64_tr_b16 a[76:77], v39 offset:61696
  ds_read_b64_tr_b16 a[78:79], v39 offset:62208
  ds_read_b64_tr_b16 a[80:81], v39 offset:16384
  ds_read_b64_tr_b16 a[82:83], v39 offset:16896
  ds_read_b64_tr_b16 a[84:85], v39 offset:16640
  ds_read_b64_tr_b16 a[86:87], v39 offset:17152
  ds_read_b64_tr_b16 a[88:89], v39 offset:20480
  ds_read_b64_tr_b16 a[90:91], v39 offset:20992
  ds_read_b64_tr_b16 a[92:93], v39 offset:20736
  ds_read_b64_tr_b16 a[94:95], v39 offset:21248
  ds_read_b64_tr_b16 a[96:97], v39 offset:24576
  ds_read_b64_tr_b16 a[98:99], v39 offset:25088
  ds_read_b64_tr_b16 a[100:101], v39 offset:24832
  ds_read_b64_tr_b16 a[102:103], v39 offset:25344
  ds_read_b64_tr_b16 a[104:105], v39 offset:28672
  ds_read_b64_tr_b16 a[106:107], v39 offset:29184
  ds_read_b64_tr_b16 a[108:109], v39 offset:28928
  ds_read_b64_tr_b16 a[110:111], v39 offset:29440
  ds_read_b64_tr_b16 a[112:113], v39 offset:32768
  ds_read_b64_tr_b16 a[114:115], v39 offset:33280
  ds_read_b64_tr_b16 a[116:117], v39 offset:33024
  ds_read_b64_tr_b16 a[118:119], v39 offset:33536
  ds_read_b64_tr_b16 a[120:121], v39 offset:36864
  ds_read_b64_tr_b16 a[122:123], v39 offset:37376
  ds_read_b64_tr_b16 a[124:125], v39 offset:37120
  ds_read_b64_tr_b16 a[126:127], v39 offset:37632
  ds_read_b64_tr_b16 a[128:129], v39 offset:40960
  ds_read_b64_tr_b16 a[130:131], v39 offset:41472
  ds_read_b64_tr_b16 a[132:133], v39 offset:41216
  ds_read_b64_tr_b16 a[134:135], v39 offset:41728
  ds_read_b64_tr_b16 a[136:137], v39 offset:45056
  ds_read_b64_tr_b16 a[138:139], v39 offset:45568
  ds_read_b64_tr_b16 a[140:141], v39 offset:45312
  ds_read_b64_tr_b16 a[142:143], v39 offset:45824
  ds_read_b64_tr_b16 a[144:145], v39 offset:49152
  ds_read_b64_tr_b16 a[146:147], v39 offset:49664
  ds_read_b64_tr_b16 a[148:149], v39 offset:49408
  ds_read_b64_tr_b16 a[150:151], v39 offset:49920
  ds_read_b64_tr_b16 a[152:153], v39 offset:53248
  ds_read_b64_tr_b16 a[154:155], v39 offset:53760
  ds_read_b64_tr_b16 a[156:157], v39 offset:53504
  ds_read_b64_tr_b16 a[158:159], v39 offset:54016
  ds_read_b64_tr_b16 a[160:161], v38 offset:0
  ds_read_b64_tr_b16 a[162:163], v38 offset:512
  ds_read_b64_tr_b16 a[164:165], v38 offset:256
  ds_read_b64_tr_b16 a[166:167], v38 offset:768
  ds_read_b64_tr_b16 a[168:169], v38 offset:4096
  ds_read_b64_tr_b16 a[170:171], v38 offset:4608
  ds_read_b64_tr_b16 a[172:173], v38 offset:4352
  ds_read_b64_tr_b16 a[174:175], v38 offset:4864
  ds_read_b64_tr_b16 a[176:177], v38 offset:8192
  ds_read_b64_tr_b16 a[178:179], v38 offset:8704
  ds_read_b64_tr_b16 a[180:181], v38 offset:8448
  ds_read_b64_tr_b16 a[182:183], v38 offset:8960
  ds_read_b64_tr_b16 a[184:185], v38 offset:12288
  ds_read_b64_tr_b16 a[186:187], v38 offset:12800
  ds_read_b64_tr_b16 a[188:189], v38 offset:12544
  ds_read_b64_tr_b16 a[190:191], v38 offset:13056
  s_waitcnt lgkmcnt(0)
  v_mfma_f32_32x32x16_bf16 v[192:207], v[16:19], v[180:183], 0
  v_mfma_f32_32x32x16_bf16 v[192:207], v[20:23], v[184:187], v[192:207]
  s_nop 11
  v_max3_f32 v2, v192, v193, v194
  v_min3_f32 v3, v192, v193, v194
  v_max3_f32 v2, v2, v195, v196
  v_min3_f32 v3, v3, v195, v196
  v_max3_f32 v2, v2, v197, v198
  v_min3_f32 v3, v3, v197, v198
  v_max3_f32 v2, v2, v199, v200
  v_min3_f32 v3, v3, v199, v200
  v_max3_f32 v2, v2, v201, v202
  v_min3_f32 v3, v3, v201, v202
  v_max3_f32 v2, v2, v203, v204
  v_min3_f32 v3, v3, v203, v204
  v_max3_f32 v2, v2, v205, v206
  v_min3_f32 v3, v3, v205, v206
  v_max_f32 v2, v2, v207
  v_min_f32 v3, v3, v207
  v_mul_f32 v4, 0xbfb8aa3b, v2
  v_mul_f32 v6, 0x3fb8aa3b, v3
  v_pk_fma_f32 v[208:209], v[192:193], s[64:65], v[4:5] op_sel_hi:[1,1,0]
  v_pk_fma_f32 v[210:211], v[194:195], s[64:65], v[4:5] op_sel_hi:[1,1,0]
  v_pk_fma_f32 v[212:213], v[196:197], s[64:65], v[4:5] op_sel_hi:[1,1,0]
  v_pk_fma_f32 v[214:215], v[198:199], s[64:65], v[4:5] op_sel_hi:[1,1,0]
  v_pk_fma_f32 v[216:217], v[200:201], s[64:65], v[4:5] op_sel_hi:[1,1,0]
  v_pk_fma_f32 v[218:219], v[202:203], s[64:65], v[4:5] op_sel_hi:[1,1,0]
  v_pk_fma_f32 v[220:221], v[204:205], s[64:65], v[4:5] op_sel_hi:[1,1,0]
  v_pk_fma_f32 v[222:223], v[206:207], s[64:65], v[4:5] op_sel_hi:[1,1,0]
  v_pk_fma_f32 v[192:193], v[192:193], s[64:65], v[6:7] op_sel_hi:[1,1,0] neg_lo:[1,0,0] neg_hi:[1,0,0]
  v_pk_fma_f32 v[194:195], v[194:195], s[64:65], v[6:7] op_sel_hi:[1,1,0] neg_lo:[1,0,0] neg_hi:[1,0,0]
  v_pk_fma_f32 v[196:197], v[196:197], s[64:65], v[6:7] op_sel_hi:[1,1,0] neg_lo:[1,0,0] neg_hi:[1,0,0]
  v_pk_fma_f32 v[198:199], v[198:199], s[64:65], v[6:7] op_sel_hi:[1,1,0] neg_lo:[1,0,0] neg_hi:[1,0,0]
  v_pk_fma_f32 v[200:201], v[200:201], s[64:65], v[6:7] op_sel_hi:[1,1,0] neg_lo:[1,0,0] neg_hi:[1,0,0]
  v_pk_fma_f32 v[202:203], v[202:203], s[64:65], v[6:7] op_sel_hi:[1,1,0] neg_lo:[1,0,0] neg_hi:[1,0,0]
  v_pk_fma_f32 v[204:205], v[204:205], s[64:65], v[6:7] op_sel_hi:[1,1,0] neg_lo:[1,0,0] neg_hi:[1,0,0]
  v_pk_fma_f32 v[206:207], v[206:207], s[64:65], v[6:7] op_sel_hi:[1,1,0] neg_lo:[1,0,0] neg_hi:[1,0,0]
  v_exp_f32 v208, v208
  v_exp_f32 v209, v209
  v_exp_f32 v210, v210
  v_exp_f32 v211, v211
  v_exp_f32 v212, v212
  v_exp_f32 v213, v213
  v_exp_f32 v214, v214
  v_exp_f32 v215, v215
  v_exp_f32 v216, v216
  v_exp_f32 v217, v217
  v_exp_f32 v218, v218
  v_exp_f32 v219, v219
  v_exp_f32 v220, v220
  v_exp_f32 v221, v221
  v_exp_f32 v222, v222
  v_exp_f32 v223, v223
  v_exp_f32 v192, v192
  v_exp_f32 v193, v193
  v_exp_f32 v194, v194
  v_exp_f32 v195, v195
  v_exp_f32 v196, v196
  v_exp_f32 v197, v197
  v_exp_f32 v198, v198
  v_exp_f32 v199, v199
  v_exp_f32 v200, v200
  v_exp_f32 v201, v201
  v_exp_f32 v202, v202
  v_exp_f32 v203, v203
  v_exp_f32 v204, v204
  v_exp_f32 v205, v205
  v_exp_f32 v206, v206
  v_exp_f32 v207, v207
  v_pk_add_f32 v[8:9], v[208:209], v[210:211]
  v_pk_add_f32 v[10:11], v[192:193], v[194:195]
  v_pk_add_f32 v[8:9], v[8:9], v[212:213]
  v_pk_add_f32 v[10:11], v[10:11], v[196:197]
  v_pk_add_f32 v[8:9], v[8:9], v[214:215]
  v_pk_add_f32 v[10:11], v[10:11], v[198:199]
  v_pk_add_f32 v[8:9], v[8:9], v[216:217]
  v_pk_add_f32 v[10:11], v[10:11], v[200:201]
  v_pk_add_f32 v[8:9], v[8:9], v[218:219]
  v_pk_add_f32 v[10:11], v[10:11], v[202:203]
  v_pk_add_f32 v[8:9], v[8:9], v[220:221]
  v_pk_add_f32 v[10:11], v[10:11], v[204:205]
  v_pk_add_f32 v[8:9], v[8:9], v[222:223]
  v_pk_add_f32 v[10:11], v[10:11], v[206:207]
  v_add_f32 v8, v8, v9
  v_add_f32 v10, v10, v11
  v_rcp_f32 v8, v8
  v_rcp_f32 v10, v10
  v_pk_mul_f32 v[208:209], v[208:209], v[8:9] op_sel_hi:[1,0]
  v_pk_mul_f32 v[210:211], v[210:211], v[8:9] op_sel_hi:[1,0]
  v_pk_mul_f32 v[212:213], v[212:213], v[8:9] op_sel_hi:[1,0]
  v_pk_mul_f32 v[214:215], v[214:215], v[8:9] op_sel_hi:[1,0]
  v_pk_mul_f32 v[216:217], v[216:217], v[8:9] op_sel_hi:[1,0]
  v_pk_mul_f32 v[218:219], v[218:219], v[8:9] op_sel_hi:[1,0]
  v_pk_mul_f32 v[220:221], v[220:221], v[8:9] op_sel_hi:[1,0]
  v_pk_mul_f32 v[222:223], v[222:223], v[8:9] op_sel_hi:[1,0]
  v_pk_mul_f32 v[192:193], v[192:193], v[10:11] op_sel_hi:[1,0]
  v_pk_mul_f32 v[194:195], v[194:195], v[10:11] op_sel_hi:[1,0]
  v_pk_mul_f32 v[196:197], v[196:197], v[10:11] op_sel_hi:[1,0]
  v_pk_mul_f32 v[198:199], v[198:199], v[10:11] op_sel_hi:[1,0]
  v_pk_mul_f32 v[200:201], v[200:201], v[10:11] op_sel_hi:[1,0]
  v_pk_mul_f32 v[202:203], v[202:203], v[10:11] op_sel_hi:[1,0]
  v_pk_mul_f32 v[204:205], v[204:205], v[10:11] op_sel_hi:[1,0]
  v_pk_mul_f32 v[206:207], v[206:207], v[10:11] op_sel_hi:[1,0]
  v_cvt_pk_bf16_f32 v208, v208, v209
  v_cvt_pk_bf16_f32 v209, v210, v211
  v_cvt_pk_bf16_f32 v210, v212, v213
  v_cvt_pk_bf16_f32 v211, v214, v215
  v_cvt_pk_bf16_f32 v212, v216, v217
  v_cvt_pk_bf16_f32 v213, v218, v219
  v_cvt_pk_bf16_f32 v214, v220, v221
  v_cvt_pk_bf16_f32 v215, v222, v223
  v_cvt_pk_bf16_f32 v192, v192, v193
  v_cvt_pk_bf16_f32 v193, v194, v195
  v_cvt_pk_bf16_f32 v194, v196, v197
  v_cvt_pk_bf16_f32 v195, v198, v199
  v_cvt_pk_bf16_f32 v196, v200, v201
  v_cvt_pk_bf16_f32 v197, v202, v203
  v_cvt_pk_bf16_f32 v198, v204, v205
  v_cvt_pk_bf16_f32 v199, v206, v207
  s_waitcnt vmcnt(2)
  s_barrier
  s_lshl_b32 s53, s39, 7
  s_add_u32 s53, s53, 12288
  s_cmp_eq_u32 s36, 0
  s_cbranch_scc0 L_sg_36
  v_mov_b32 v14, s53
  v_mov_b32 v15, 1
  s_mov_b64 exec, 1
  buffer_atomic_add v15, v14, s[12:15], 0 offen sc1
  s_mov_b64 exec, -1
L_sg_36:
  s_mov_b32 s59, 1048576
  s_add_u32 m0, s52, 122880
  s_nop 0
  buffer_load_dwordx4 v31, s[16:19], s59 offen lds
  s_mov_b32 s59, 1081344
  s_add_u32 m0, s52, 126976
  s_nop 0
  buffer_load_dwordx4 v31, s[16:19], s59 offen lds
  s_mov_b32 s59, 1114112
  s_add_u32 m0, s52, 81920
  s_nop 0
  buffer_load_dwordx4 v31, s[16:19], s59 offen lds
  s_mov_b32 s59, 1146880
  s_add_u32 m0, s52, 86016
  s_nop 0
  buffer_load_dwordx4 v31, s[16:19], s59 offen lds
  s_mov_b32 s59, 1179648
  s_add_u32 m0, s52, 90112
  s_nop 0
  buffer_load_dwordx4 v31, s[16:19], s59 offen lds
  s_mov_b32 s59, 1212416
  s_add_u32 m0, s52, 94208
  s_nop 0
  buffer_load_dwordx4 v31, s[16:19], s59 offen lds
  s_mov_b32 s59, 1245184
  s_add_u32 m0, s52, 98304
  s_nop 0
  buffer_load_dwordx4 v31, s[16:19], s59 offen lds
  s_mov_b32 s59, 1277952
  s_add_u32 m0, s52, 102400
  s_nop 0
  buffer_load_dwordx4 v31, s[16:19], s59 offen lds
  s_lshl_b32 s55, s45, 7
  s_add_u32 s55, s55, 4096
  s_cmp_eq_u32 s36, 0
  s_cbranch_scc0 L_pi_37
  v_mov_b32 v12, s55
  s_mov_b64 exec, 1
  buffer_load_dword v13, v12, s[12:15], 0 offen sc1
  s_mov_b64 exec, -1
L_pi_37:
L_p2:
  s_mul_i32 s70, s92, 120832
  s_add_u32 s70, s70, 4194304
  s_lshl_b32 s53, s42, 10
  s_add_u32 s71, s70, s53
  s_cmp_eq_u32 s36, 0
  s_cbranch_scc0 L_pc_38
  s_waitcnt vmcnt(0)
  s_mov_b64 exec, 1
  v_cmp_ne_u32 vcc, 8, v13
  s_cbranch_vccz L_chd_40
  s_mov_b32 s60, 0
L_ch_39:
  buffer_load_dword v13, v12, s[12:15], 0 offen sc1
  s_add_u32 s60, s60, 1
  s_waitcnt vmcnt(0)
  v_cmp_ne_u32 vcc, 8, v13
  s_cmp_gt_u32 s60, 0x20000
  s_cbranch_scc1 L_chd_40
  s_cbranch_vccnz L_ch_39
L_chd_40:
  s_mov_b64 exec, -1
L_pc_38:
  s_barrier
  s_add_u32 s58, s71, 0
  buffer_load_dwordx4 a[0:3], v41, s[12:15], s58 offen sc1
  s_add_u32 s58, s71, 2048
  buffer_load_dwordx4 a[4:7], v41, s[12:15], s58 offen sc1
  s_add_u32 s58, s71, 4096
  buffer_load_dwordx4 a[8:11], v41, s[12:15], s58 offen sc1
  s_add_u32 s58, s71, 6144
  buffer_load_dwordx4 a[12:15], v41, s[12:15], s58 offen sc1
  s_add_u32 s58, s71, 8192
  buffer_load_dwordx4 a[16:19], v41, s[12:15], s58 offen sc1
  s_add_u32 s58, s71, 10240
  buffer_load_dwordx4 a[20:23], v41, s[12:15], s58 offen sc1
  s_add_u32 s58, s71, 12288
  buffer_load_dwordx4 a[24:27], v41, s[12:15], s58 offen sc1
  s_add_u32 s58, s71, 14336
  buffer_load_dwordx4 a[28:31], v41, s[12:15], s58 offen sc1
  s_add_u32 s58, s71, 16384
  buffer_load_dwordx4 a[32:35], v41, s[12:15], s58 offen sc1
  s_add_u32 s58, s71, 18432
  buffer_load_dwordx4 a[36:39], v41, s[12:15], s58 offen sc1
  s_add_u32 s58, s71, 20480
  buffer_load_dwordx4 a[40:43], v41, s[12:15], s58 offen sc1
  s_add_u32 s58, s71, 22528
  buffer_load_dwordx4 a[44:47], v41, s[12:15], s58 offen sc1
  s_waitcnt vmcnt(11)
  v_mfma_f32_32x32x16_bf16 v[96:111], a[64:67], a[0:3], 0
  v_mfma_f32_32x32x16_bf16 v[112:127], a[68:71], a[0:3], 0
  s_add_u32 s58, s71, 24576
  buffer_load_dwordx4 a[48:51], v41, s[12:15], s58 offen sc1
  s_mov_b32 s59, 1310720
  s_add_u32 m0, s52, 106496
  s_nop 0
  buffer_load_dwordx4 v31, s[16:19], s59 offen lds
  s_waitcnt vmcnt(12)
  v_mfma_f32_32x32x16_bf16 v[96:111], a[72:75], a[4:7], v[96:111]
  v_mfma_f32_32x32x16_bf16 v[112:127], a[76:79], a[4:7], v[112:127]
  s_add_u32 s58, s71, 26624
  buffer_load_dwordx4 a[52:55], v41, s[12:15], s58 offen sc1
  s_mov_b32 s59, 1343488
  s_add_u32 m0, s52, 110592
  s_nop 0
  buffer_load_dwordx4 v31, s[16:19], s59 offen lds
  s_waitcnt vmcnt(13)
  v_mfma_f32_32x32x16_bf16 v[96:111], a[80:83], a[8:11], v[96:111]
  v_mfma_f32_32x32x16_bf16 v[112:127], a[84:87], a[8:11], v[112:127]
  s_add_u32 s58, s71, 28672
  buffer_load_dwordx4 a[56:59], v41, s[12:15], s58 offen sc1
  s_mov_b32 s59, 1376256
  s_add_u32 m0, s52, 114688
  s_nop 0
  buffer_load_dwordx4 v31, s[16:19], s59 offen lds
  s_cmp_eq_u32 s40, 0
  s_cbranch_scc1 L_pq_41
  v_mfma_f32_32x32x16_bf16 v[192:207], v[16:19], v[180:183], 0
  v_mfma_f32_32x32x16_bf16 v[192:207], v[20:23], v[184:187], v[192:207]
  s_nop 11
  v_max3_f32 v2, v192, v193, v194
  v_min3_f32 v3, v192, v193, v194
  s_nop 0
  v_max3_f32 v2, v2, v195, v196
  v_min3_f32 v3, v3, v195, v196
  v_max3_f32 v2, v2, v197, v198
  v_min3_f32 v3, v3, v197, v198
  v_max3_f32 v2, v2, v199, v200
  v_min3_f32 v3, v3, v199, v200
  v_max3_f32 v2, v2, v201, v202
  v_min3_f32 v3, v3, v201, v202
  v_max3_f32 v2, v2, v203, v204
  v_min3_f32 v3, v3, v203, v204
  v_max3_f32 v2, v2, v205, v206
  v_min3_f32 v3, v3, v205, v206
  v_max_f32 v2, v2, v207
  v_min_f32 v3, v3, v207
  v_mul_f32 v4, 0xbfb8aa3b, v2
  v_mul_f32 v6, 0x3fb8aa3b, v3
  v_pk_fma_f32 v[208:209], v[192:193], s[64:65], v[4:5] op_sel_hi:[1,1,0]
  v_pk_fma_f32 v[210:211], v[194:195], s[64:65], v[4:5] op_sel_hi:[1,1,0]
  v_pk_fma_f32 v[212:213], v[196:197], s[64:65], v[4:5] op_sel_hi:[1,1,0]
  v_pk_fma_f32 v[214:215], v[198:199], s[64:65], v[4:5] op_sel_hi:[1,1,0]
  v_pk_fma_f32 v[216:217], v[200:201], s[64:65], v[4:5] op_sel_hi:[1,1,0]
  v_pk_fma_f32 v[218:219], v[202:203], s[64:65], v[4:5] op_sel_hi:[1,1,0]
  v_pk_fma_f32 v[220:221], v[204:205], s[64:65], v[4:5] op_sel_hi:[1,1,0]
  v_pk_fma_f32 v[222:223], v[206:207], s[64:65], v[4:5] op_sel_hi:[1,1,0]
  v_pk_fma_f32 v[192:193], v[192:193], s[64:65], v[6:7] op_sel_hi:[1,1,0] neg_lo:[1,0,0] neg_hi:[1,0,0]
  v_pk_fma_f32 v[194:195], v[194:195], s[64:65], v[6:7] op_sel_hi:[1,1,0] neg_lo:[1,0,0] neg_hi:[1,0,0]
  v_pk_fma_f32 v[196:197], v[196:197], s[64:65], v[6:7] op_sel_hi:[1,1,0] neg_lo:[1,0,0] neg_hi:[1,0,0]
  v_pk_fma_f32 v[198:199], v[198:199], s[64:65], v[6:7] op_sel_hi:[1,1,0] neg_lo:[1,0,0] neg_hi:[1,0,0]
  v_pk_fma_f32 v[200:201], v[200:201], s[64:65], v[6:7] op_sel_hi:[1,1,0] neg_lo:[1,0,0] neg_hi:[1,0,0]
  v_pk_fma_f32 v[202:203], v[202:203], s[64:65], v[6:7] op_sel_hi:[1,1,0] neg_lo:[1,0,0] neg_hi:[1,0,0]
  v_pk_fma_f32 v[204:205], v[204:205], s[64:65], v[6:7] op_sel_hi:[1,1,0] neg_lo:[1,0,0] neg_hi:[1,0,0]
  v_pk_fma_f32 v[206:207], v[206:207], s[64:65], v[6:7] op_sel_hi:[1,1,0] neg_lo:[1,0,0] neg_hi:[1,0,0]
  v_exp_f32 v208, v208
  v_exp_f32 v209, v209
  v_exp_f32 v210, v210
  v_exp_f32 v211, v211
  v_exp_f32 v212, v212
  v_exp_f32 v213, v213
  v_exp_f32 v214, v214
  v_exp_f32 v215, v215
  v_exp_f32 v216, v216
  v_exp_f32 v217, v217
  v_exp_f32 v218, v218
  v_exp_f32 v219, v219
  v_exp_f32 v220, v220
  v_exp_f32 v221, v221
  v_exp_f32 v222, v222
  v_exp_f32 v223, v223
  v_exp_f32 v192, v192
  v_exp_f32 v193, v193
  v_exp_f32 v194, v194
  v_exp_f32 v195, v195
  v_exp_f32 v196, v196
  v_exp_f32 v197, v197
  v_exp_f32 v198, v198
  v_exp_f32 v199, v199
  v_exp_f32 v200, v200
  v_exp_f32 v201, v201
  v_exp_f32 v202, v202
  v_exp_f32 v203, v203
  v_exp_f32 v204, v204
  v_exp_f32 v205, v205
  v_exp_f32 v206, v206
  v_exp_f32 v207, v207
  v_pk_add_f32 v[8:9], v[208:209], v[210:211]
  v_pk_add_f32 v[10:11], v[192:193], v[194:195]
  v_pk_add_f32 v[8:9], v[8:9], v[212:213]
  v_pk_add_f32 v[10:11], v[10:11], v[196:197]
  v_pk_add_f32 v[8:9], v[8:9], v[214:215]
  v_pk_add_f32 v[10:11], v[10:11], v[198:199]
  v_pk_add_f32 v[8:9], v[8:9], v[216:217]
  v_pk_add_f32 v[10:11], v[10:11], v[200:201]
  v_pk_add_f32 v[8:9], v[8:9], v[218:219]
  v_pk_add_f32 v[10:11], v[10:11], v[202:203]
  v_pk_add_f32 v[8:9], v[8:9], v[220:221]
  v_pk_add_f32 v[10:11], v[10:11], v[204:205]
  v_pk_add_f32 v[8:9], v[8:9], v[222:223]
  v_pk_add_f32 v[10:11], v[10:11], v[206:207]
  v_add_f32 v8, v8, v9
  v_add_f32 v10, v10, v11
  v_rcp_f32 v8, v8
  v_rcp_f32 v10, v10
  v_pk_mul_f32 v[208:209], v[208:209], v[8:9] op_sel_hi:[1,0]
  v_pk_mul_f32 v[210:211], v[210:211], v[8:9] op_sel_hi:[1,0]
  v_pk_mul_f32 v[212:213], v[212:213], v[8:9] op_sel_hi:[1,0]
  v_pk_mul_f32 v[214:215], v[214:215], v[8:9] op_sel_hi:[1,0]
  v_pk_mul_f32 v[216:217], v[216:217], v[8:9] op_sel_hi:[1,0]
  v_pk_mul_f32 v[218:219], v[218:219], v[8:9] op_sel_hi:[1,0]
  v_pk_mul_f32 v[220:221], v[220:221], v[8:9] op_sel_hi:[1,0]
  v_pk_mul_f32 v[222:223], v[222:223], v[8:9] op_sel_hi:[1,0]
  v_pk_mul_f32 v[192:193], v[192:193], v[10:11] op_sel_hi:[1,0]
  v_pk_mul_f32 v[194:195], v[194:195], v[10:11] op_sel_hi:[1,0]
  v_pk_mul_f32 v[196:197], v[196:197], v[10:11] op_sel_hi:[1,0]
  v_pk_mul_f32 v[198:199], v[198:199], v[10:11] op_sel_hi:[1,0]
  v_pk_mul_f32 v[200:201], v[200:201], v[10:11] op_sel_hi:[1,0]
  v_pk_mul_f32 v[202:203], v[202:203], v[10:11] op_sel_hi:[1,0]
  v_pk_mul_f32 v[204:205], v[204:205], v[10:11] op_sel_hi:[1,0]
  v_pk_mul_f32 v[206:207], v[206:207], v[10:11] op_sel_hi:[1,0]
  v_cvt_pk_bf16_f32 v208, v208, v209
  v_cvt_pk_bf16_f32 v209, v210, v211
  v_cvt_pk_bf16_f32 v210, v212, v213
  v_cvt_pk_bf16_f32 v211, v214, v215
  v_cvt_pk_bf16_f32 v212, v216, v217
  v_cvt_pk_bf16_f32 v213, v218, v219
  v_cvt_pk_bf16_f32 v214, v220, v221
  v_cvt_pk_bf16_f32 v215, v222, v223
  v_cvt_pk_bf16_f32 v192, v192, v193
  v_cvt_pk_bf16_f32 v193, v194, v195
  v_cvt_pk_bf16_f32 v194, v196, v197
  v_cvt_pk_bf16_f32 v195, v198, v199
  v_cvt_pk_bf16_f32 v196, v200, v201
  v_cvt_pk_bf16_f32 v197, v202, v203
  v_cvt_pk_bf16_f32 v198, v204, v205
  v_cvt_pk_bf16_f32 v199, v206, v207
L_pq_41:
  s_waitcnt vmcnt(14)
  v_mfma_f32_32x32x16_bf16 v[96:111], a[88:91], a[12:15], v[96:111]
  v_mfma_f32_32x32x16_bf16 v[112:127], a[92:95], a[12:15], v[112:127]
  s_add_u32 s58, s71, 30720
  buffer_load_dwordx4 a[60:63], v41, s[12:15], s58 offen sc1
  s_mov_b32 s59, 0
  s_add_u32 m0, s52, 118784
  s_nop 0
  buffer_load_dwordx4 v31, s[20:23], s59 offen lds
  s_waitcnt vmcnt(15)
  v_mfma_f32_32x32x16_bf16 v[96:111], a[96:99], a[16:19], v[96:111]
  v_mfma_f32_32x32x16_bf16 v[112:127], a[100:103], a[16:19], v[112:127]
  s_add_u32 s58, s71, 32768
  buffer_load_dwordx4 a[0:3], v41, s[12:15], s58 offen sc1
  s_mov_b32 s59, 32768
  s_add_u32 m0, s52, 0
  s_nop 0
  buffer_load_dwordx4 v31, s[20:23], s59 offen lds
  s_waitcnt vmcnt(16)
  v_mfma_f32_32x32x16_bf16 v[96:111], a[104:107], a[20:23], v[96:111]
  v_mfma_f32_32x32x16_bf16 v[112:127], a[108:111], a[20:23], v[112:127]
  s_add_u32 s58, s71, 34816
  buffer_load_dwordx4 a[4:7], v41, s[12:15], s58 offen sc1
  s_mov_b32 s59, 65536
  s_add_u32 m0, s52, 4096
  s_nop 0
  buffer_load_dwordx4 v31, s[20:23], s59 offen lds
  s_waitcnt vmcnt(17)
  v_mfma_f32_32x32x16_bf16 v[96:111], a[112:115], a[24:27], v[96:111]
  v_mfma_f32_32x32x16_bf16 v[112:127], a[116:119], a[24:27], v[112:127]
  s_add_u32 s58, s71, 36864
  buffer_load_dwordx4 a[8:11], v41, s[12:15], s58 offen sc1
  s_mov_b32 s59, 98304
  s_add_u32 m0, s52, 8192
  s_nop 0
  buffer_load_dwordx4 v31, s[20:23], s59 offen lds
  s_lshl_b32 s55, s39, 7
  s_add_u32 s55, s55, 12288
  s_cmp_eq_u32 s36, 0
  s_cbranch_scc0 L_pi_42
  v_mov_b32_e64 v12, s55
  s_mov_b64 exec, 1
  buffer_load_dword v13, v12, s[12:15], 0 offen sc1
  s_mov_b64 exec, -1
L_pi_42:
  s_waitcnt vmcnt(18)
  v_mfma_f32_32x32x16_bf16 v[96:111], a[120:123], a[28:31], v[96:111]
  v_mfma_f32_32x32x16_bf16 v[112:127], a[124:127], a[28:31], v[112:127]
  s_add_u32 s58, s71, 38912
  buffer_load_dwordx4 a[12:15], v41, s[12:15], s58 offen sc1
  s_mov_b32 s59, 131072
  s_add_u32 m0, s52, 12288
  s_nop 0
  buffer_load_dwordx4 v31, s[20:23], s59 offen lds
  s_waitcnt vmcnt(19)
  v_mfma_f32_32x32x16_bf16 v[96:111], a[128:131], a[32:35], v[96:111]
  v_mfma_f32_32x32x16_bf16 v[112:127], a[132:135], a[32:35], v[112:127]
  s_add_u32 s58, s71, 40960
  buffer_load_dwordx4 a[16:19], v41, s[12:15], s58 offen sc1
  s_waitcnt vmcnt(19)
  v_mfma_f32_32x32x16_bf16 v[96:111], a[136:139], a[36:39], v[96:111]
  v_mfma_f32_32x32x16_bf16 v[112:127], a[140:143], a[36:39], v[112:127]
  s_add_u32 s58, s71, 43008
  buffer_load_dwordx4 a[20:23], v41, s[12:15], s58 offen sc1
  s_waitcnt vmcnt(19)
  v_mfma_f32_32x32x16_bf16 v[96:111], a[144:147], a[40:43], v[96:111]
  v_mfma_f32_32x32x16_bf16 v[112:127], a[148:151], a[40:43], v[112:127]
  s_add_u32 s58, s71, 45056
  buffer_load_dwordx4 a[24:27], v41, s[12:15], s58 offen sc1
  s_waitcnt vmcnt(19)
  v_mfma_f32_32x32x16_bf16 v[96:111], a[152:155], a[44:47], v[96:111]
  v_mfma_f32_32x32x16_bf16 v[112:127], a[156:159], a[44:47], v[112:127]
  s_add_u32 s58, s71, 47104
  buffer_load_dwordx4 a[28:31], v41, s[12:15], s58 offen sc1
  s_cmp_eq_u32 s36, 0
  s_cbranch_scc0 L_pc_43
  s_waitcnt vmcnt(6)
  s_mov_b64 exec, 1
  v_cmp_ne_u32 vcc, 16, v13
  s_cbranch_vccz L_ckvd_45
  s_mov_b32 s60, 0
L_ckv_44:
  buffer_load_dword v13, v12, s[12:15], 0 offen sc1
  s_add_u32 s60, s60, 1
  s_waitcnt vmcnt(0)
  v_cmp_ne_u32 vcc, 16, v13
  s_cmp_gt_u32 s60, 0x20000
  s_cbranch_scc1 L_ckvd_45
  s_cbranch_vccnz L_ckv_44
L_ckvd_45:
  s_mov_b64 exec, -1
L_pc_43:
  s_barrier
  s_nop 0
  s_mul_i32 s53, s39, 8704
  s_add_u32 s53, s53, 32768
  buffer_load_dwordx4 v[128:131], v172, s[12:15], s53 offen sc1
  s_add_u32 s54, s53, 4096
  buffer_load_dwordx4 v[132:135], v172, s[12:15], s54 offen sc1
  s_cmp_eq_u32 s36, 0
  s_cbranch_scc0 L_k3_46
  s_add_u32 s54, s53, 8192
  s_mov_b64 exec, s[68:69]
  buffer_load_dwordx4 v[136:139], v172, s[12:15], s54 offen sc1
  s_mov_b64 exec, -1
L_k3_46:
  s_waitcnt vmcnt(21)
  v_mfma_f32_32x32x16_bf16 v[96:111], a[160:163], a[48:51], v[96:111]
  v_mfma_f32_32x32x16_bf16 v[112:127], a[164:167], a[48:51], v[112:127]
  s_add_u32 s58, s71, 49152
  buffer_load_dwordx4 a[32:35], v41, s[12:15], s58 offen sc1
  s_waitcnt vmcnt(20)
  v_mfma_f32_32x32x16_bf16 v[96:111], a[168:171], a[52:55], v[96:111]
  ds_read_b64_tr_b16 v[48:49], v38 offset:16384
  ds_read_b64_tr_b16 v[50:51], v38 offset:16896
  v_mfma_f32_32x32x16_bf16 v[112:127], a[172:175], a[52:55], v[112:127]
  ds_read_b64_tr_b16 v[52:53], v38 offset:16640
  ds_read_b64_tr_b16 v[54:55], v38 offset:17152
  s_add_u32 s58, s71, 51200
  buffer_load_dwordx4 a[36:39], v41, s[12:15], s58 offen sc1
  s_waitcnt vmcnt(19)
  v_mfma_f32_32x32x16_bf16 v[96:111], a[176:179], a[56:59], v[96:111]
  ds_read_b64_tr_b16 v[56:57], v38 offset:20480
  ds_read_b64_tr_b16 v[58:59], v38 offset:20992
  v_mfma_f32_32x32x16_bf16 v[112:127], a[180:183], a[56:59], v[112:127]
  ds_read_b64_tr_b16 v[60:61], v38 offset:20736
  ds_read_b64_tr_b16 v[62:63], v38 offset:21248
  s_add_u32 s58, s71, 53248
  buffer_load_dwordx4 a[40:43], v41, s[12:15], s58 offen sc1
  s_waitcnt vmcnt(18)
  v_mfma_f32_32x32x16_bf16 v[96:111], a[184:187], a[60:63], v[96:111]
  ds_read_b64_tr_b16 v[64:65], v38 offset:24576
  ds_read_b64_tr_b16 v[66:67], v38 offset:25088
  v_mfma_f32_32x32x16_bf16 v[112:127], a[188:191], a[60:63], v[112:127]
  ds_read_b64_tr_b16 v[68:69], v38 offset:24832
  ds_read_b64_tr_b16 v[70:71], v38 offset:25344
  s_add_u32 s58, s71, 55296
  buffer_load_dwordx4 a[44:47], v41, s[12:15], s58 offen sc1
  s_waitcnt lgkmcnt(10)
  s_waitcnt vmcnt(17)
  v_mfma_f32_32x32x16_bf16 v[96:111], v[48:51], a[0:3], v[96:111]
  ds_read_b64_tr_b16 v[72:73], v38 offset:28672
  ds_read_b64_tr_b16 v[74:75], v38 offset:29184
  s_waitcnt lgkmcnt(10)
  v_mfma_f32_32x32x16_bf16 v[112:127], v[52:55], a[0:3], v[112:127]
  ds_read_b64_tr_b16 v[76:77], v38 offset:28928
  ds_read_b64_tr_b16 v[78:79], v38 offset:29440
  s_add_u32 s58, s71, 57344
  buffer_load_dwordx4 a[48:51], v41, s[12:15], s58 offen sc1
  s_waitcnt lgkmcnt(10)
  s_waitcnt vmcnt(16)
  v_mfma_f32_32x32x16_bf16 v[96:111], v[56:59], a[4:7], v[96:111]
  ds_read_b64_tr_b16 v[48:49], v38 offset:32768
  ds_read_b64_tr_b16 v[50:51], v38 offset:33280
  s_waitcnt lgkmcnt(10)
  v_mfma_f32_32x32x16_bf16 v[112:127], v[60:63], a[4:7], v[112:127]
  ds_read_b64_tr_b16 v[52:53], v38 offset:33024
  ds_read_b64_tr_b16 v[54:55], v38 offset:33536
  s_add_u32 s58, s71, 59392
  buffer_load_dwordx4 a[52:55], v41, s[12:15], s58 offen sc1
  s_waitcnt lgkmcnt(10)
  s_waitcnt vmcnt(15)
  v_mfma_f32_32x32x16_bf16 v[96:111], v[64:67], a[8:11], v[96:111]
  ds_read_b64_tr_b16 v[56:57], v38 offset:36864
  ds_read_b64_tr_b16 v[58:59], v38 offset:37376
  s_waitcnt lgkmcnt(10)
  v_mfma_f32_32x32x16_bf16 v[112:127], v[68:71], a[8:11], v[112:127]
  ds_read_b64_tr_b16 v[60:61], v38 offset:37120
  ds_read_b64_tr_b16 v[62:63], v38 offset:37632
  s_add_u32 s58, s71, 61440
  buffer_load_dwordx4 a[56:59], v41, s[12:15], s58 offen sc1
  s_waitcnt lgkmcnt(10)
  s_waitcnt vmcnt(14)
  v_mfma_f32_32x32x16_bf16 v[96:111], v[72:75], a[12:15], v[96:111]
  ds_read_b64_tr_b16 v[64:65], v38 offset:40960
  ds_read_b64_tr_b16 v[66:67], v38 offset:41472
  s_waitcnt lgkmcnt(10)
  v_mfma_f32_32x32x16_bf16 v[112:127], v[76:79], a[12:15], v[112:127]
  ds_read_b64_tr_b16 v[68:69], v38 offset:41216
  ds_read_b64_tr_b16 v[70:71], v38 offset:41728
  s_add_u32 s58, s71, 63488
  buffer_load_dwordx4 a[60:63], v41, s[12:15], s58 offen sc1
  v_mov_b32 v2, 0
  v_mov_b32 v3, 0
  v_lshlrev_b32_e64 v4, 3, v1
  v_add_u32 v4, 136512, v4
  s_mov_b64 exec, 0xff
  ds_write_b64 v4, v[2:3]
  s_mov_b64 exec, -1
  s_waitcnt vmcnt(8)
  v_cvt_pk_bf16_f32 v128, v128, v129
  v_cvt_pk_bf16_f32 v129, v130, v131
  ds_write_b64 v173, v[128:129] offset:0
  v_cvt_pk_bf16_f32 v132, v132, v133
  v_cvt_pk_bf16_f32 v133, v134, v135
  ds_write_b64 v173, v[132:133] offset:2560
  s_cmp_eq_u32 s36, 0
  s_cbranch_scc0 L_k3w_47
  s_waitcnt vmcnt(8)
  v_cvt_pk_bf16_f32 v136, v136, v137
  v_cvt_pk_bf16_f32 v137, v138, v139
  s_mov_b64 exec, s[68:69]
  ds_write_b64 v173, v[136:137] offset:5120
  s_mov_b64 exec, -1
L_k3w_47:
  s_waitcnt lgkmcnt(0)
  s_barrier
  s_nop 0
  ds_read_b128 v[176:179], v171 offset:0
  ds_read_b128 v[180:183], v171 offset:16
  ds_read_b128 v[184:187], v171 offset:32
  ds_read_b128 v[188:191], v171 offset:48
  ds_read_b128 v[80:83], v170 offset:0
  ds_read_b128 v[84:87], v170 offset:16
  ds_read_b128 v[88:91], v170 offset:32
  ds_read_b128 v[92:95], v170 offset:48
  s_waitcnt lgkmcnt(4)
  v_mfma_f32_32x32x16_bf16 v[240:255], v[176:179], v[208:211], 0
  v_mfma_f32_32x32x16_bf16 v[240:255], v[180:183], v[212:215], v[240:255]
  v_mfma_f32_32x32x16_bf16 v[240:255], v[184:187], v[192:195], v[240:255]
  v_mfma_f32_32x32x16_bf16 v[240:255], v[188:191], v[196:199], v[240:255]
  s_waitcnt lgkmcnt(0)
  v_mfma_f32_32x32x16_bf16 v[224:239], v[80:83], v[208:211], 0
  v_mfma_f32_32x32x16_bf16 v[224:239], v[84:87], v[212:215], v[224:239]
  v_mfma_f32_32x32x16_bf16 v[224:239], v[88:91], v[192:195], v[224:239]
  v_mfma_f32_32x32x16_bf16 v[224:239], v[92:95], v[196:199], v[224:239]
  s_nop 6
  v_add_f32 v2, 0x358637bd, v240
  v_rcp_f32_e64 v2, v2
  s_lshl_b32 s53, s93, 11
  s_add_u32 s53, s53, 88064
  s_add_u32 s53, s53, s70
  v_pk_mul_f32 v[224:225], v[224:225], v[2:3] op_sel_hi:[1,0]
  v_pk_mul_f32 v[226:227], v[226:227], v[2:3] op_sel_hi:[1,0]
  v_pk_mul_f32 v[228:229], v[228:229], v[2:3] op_sel_hi:[1,0]
  v_pk_mul_f32 v[230:231], v[230:231], v[2:3] op_sel_hi:[1,0]
  v_pk_mul_f32 v[232:233], v[232:233], v[2:3] op_sel_hi:[1,0]
  v_pk_mul_f32 v[234:235], v[234:235], v[2:3] op_sel_hi:[1,0]
  v_pk_mul_f32 v[236:237], v[236:237], v[2:3] op_sel_hi:[1,0]
  v_pk_mul_f32 v[238:239], v[238:239], v[2:3] op_sel_hi:[1,0]
  v_cvt_pk_bf16_f32 v224, v224, v225
  v_cvt_pk_bf16_f32 v225, v226, v227
  v_cvt_pk_bf16_f32 v226, v228, v229
  v_cvt_pk_bf16_f32 v227, v230, v231
  v_cvt_pk_bf16_f32 v228, v232, v233
  v_cvt_pk_bf16_f32 v229, v234, v235
  v_cvt_pk_bf16_f32 v230, v236, v237
  v_cvt_pk_bf16_f32 v231, v238, v239
  buffer_store_dwordx4 v[224:227], v41, s[12:15], s53 offen sc1
  buffer_store_dwordx4 v[228:231], v41, s[12:15], s53 offen offset:1024 sc1
  v_mfma_f32_32x32x16_bf16 v[96:111], v[48:51], a[16:19], v[96:111]
  ds_read_b64_tr_b16 v[72:73], v38 offset:45056
  ds_read_b64_tr_b16 v[74:75], v38 offset:45568
  v_mfma_f32_32x32x16_bf16 v[112:127], v[52:55], a[16:19], v[112:127]
  ds_read_b64_tr_b16 v[76:77], v38 offset:45312
  ds_read_b64_tr_b16 v[78:79], v38 offset:45824
  s_add_u32 s58, s71, 65536
  buffer_load_dwordx4 a[0:3], v41, s[12:15], s58 offen sc1
  v_mfma_f32_32x32x16_bf16 v[96:111], v[56:59], a[20:23], v[96:111]
  ds_read_b64_tr_b16 v[48:49], v38 offset:49152
  ds_read_b64_tr_b16 v[50:51], v38 offset:49664
  v_mfma_f32_32x32x16_bf16 v[112:127], v[60:63], a[20:23], v[112:127]
  ds_read_b64_tr_b16 v[52:53], v38 offset:49408
  ds_read_b64_tr_b16 v[54:55], v38 offset:49920
  s_add_u32 s58, s71, 67584
  buffer_load_dwordx4 a[4:7], v41, s[12:15], s58 offen sc1
  v_mfma_f32_32x32x16_bf16 v[96:111], v[64:67], a[24:27], v[96:111]
  ds_read_b64_tr_b16 v[56:57], v38 offset:53248
  ds_read_b64_tr_b16 v[58:59], v38 offset:53760
  v_mfma_f32_32x32x16_bf16 v[112:127], v[68:71], a[24:27], v[112:127]
  ds_read_b64_tr_b16 v[60:61], v38 offset:53504
  ds_read_b64_tr_b16 v[62:63], v38 offset:54016
  s_add_u32 s58, s71, 69632
  buffer_load_dwordx4 a[8:11], v41, s[12:15], s58 offen sc1
  s_waitcnt lgkmcnt(10)
  v_mfma_f32_32x32x16_bf16 v[96:111], v[72:75], a[28:31], v[96:111]
  ds_read_b64_tr_b16 v[64:65], v38 offset:57344
  ds_read_b64_tr_b16 v[66:67], v38 offset:57856
  s_waitcnt lgkmcnt(10)
  v_mfma_f32_32x32x16_bf16 v[112:127], v[76:79], a[28:31], v[112:127]
  ds_read_b64_tr_b16 v[68:69], v38 offset:57600
  ds_read_b64_tr_b16 v[70:71], v38 offset:58112
  s_add_u32 s58, s71, 71680
  buffer_load_dwordx4 a[12:15], v41, s[12:15], s58 offen sc1
  s_waitcnt lgkmcnt(10)
  s_waitcnt vmcnt(13)
  v_mfma_f32_32x32x16_bf16 v[96:111], v[48:51], a[32:35], v[96:111]
  ds_read_b64_tr_b16 v[72:73], v38 offset:61440
  ds_read_b64_tr_b16 v[74:75], v38 offset:61952
  s_waitcnt lgkmcnt(10)
  v_mfma_f32_32x32x16_bf16 v[112:127], v[52:55], a[32:35], v[112:127]
  ds_read_b64_tr_b16 v[76:77], v38 offset:61696
  ds_read_b64_tr_b16 v[78:79], v38 offset:62208
  s_add_u32 s58, s71, 73728
  buffer_load_dwordx4 a[16:19], v41, s[12:15], s58 offen sc1
  s_waitcnt lgkmcnt(10)
  s_waitcnt vmcnt(13)
  v_mfma_f32_32x32x16_bf16 v[96:111], v[56:59], a[36:39], v[96:111]
  ds_read_b64_tr_b16 v[48:49], v39 offset:0
  ds_read_b64_tr_b16 v[50:51], v39 offset:512
  s_waitcnt lgkmcnt(10)
  v_mfma_f32_32x32x16_bf16 v[112:127], v[60:63], a[36:39], v[112:127]
  ds_read_b64_tr_b16 v[52:53], v39 offset:256
  ds_read_b64_tr_b16 v[54:55], v39 offset:768
  s_add_u32 s58, s71, 75776
  buffer_load_dwordx4 a[20:23], v41, s[12:15], s58 offen sc1
  s_waitcnt lgkmcnt(10)
  s_waitcnt vmcnt(13)
  v_mfma_f32_32x32x16_bf16 v[96:111], v[64:67], a[40:43], v[96:111]
  ds_read_b64_tr_b16 v[56:57], v39 offset:4096
  ds_read_b64_tr_b16 v[58:59], v39 offset:4608
  s_waitcnt lgkmcnt(10)
  v_mfma_f32_32x32x16_bf16 v[112:127], v[68:71], a[40:43], v[112:127]
  ds_read_b64_tr_b16 v[60:61], v39 offset:4352
  ds_read_b64_tr_b16 v[62:63], v39 offset:4864
  s_add_u32 s58, s71, 77824
  buffer_load_dwordx4 a[24:27], v41, s[12:15], s58 offen sc1
  s_waitcnt lgkmcnt(10)
  s_waitcnt vmcnt(13)
  v_mfma_f32_32x32x16_bf16 v[96:111], v[72:75], a[44:47], v[96:111]
  ds_read_b64_tr_b16 v[64:65], v39 offset:8192
  ds_read_b64_tr_b16 v[66:67], v39 offset:8704
  s_waitcnt lgkmcnt(10)
  v_mfma_f32_32x32x16_bf16 v[112:127], v[76:79], a[44:47], v[112:127]
  ds_read_b64_tr_b16 v[68:69], v39 offset:8448
  ds_read_b64_tr_b16 v[70:71], v39 offset:8960
  s_add_u32 s58, s71, 79872
  buffer_load_dwordx4 a[28:31], v41, s[12:15], s58 offen sc1
  s_waitcnt vmcnt(8)
  s_barrier
  s_lshl_b32 s53, s45, 7
  s_add_u32 s53, s53, 16384
  s_cmp_eq_u32 s36, 0
  s_cbranch_scc0 L_sg_48
  v_mov_b32 v14, s53
  v_mov_b32_e64 v15, 1
  s_mov_b64 exec, 1
  buffer_atomic_add v15, v14, s[12:15], 0 offen sc1
  s_mov_b64 exec, -1
L_sg_48:
  s_waitcnt lgkmcnt(10)
  v_mfma_f32_32x32x16_bf16 v[96:111], v[48:51], a[48:51], v[96:111]
  ds_read_b64_tr_b16 v[72:73], v39 offset:12288
  ds_read_b64_tr_b16 v[74:75], v39 offset:12800
  s_waitcnt lgkmcnt(10)
  v_mfma_f32_32x32x16_bf16 v[112:127], v[52:55], a[48:51], v[112:127]
  ds_read_b64_tr_b16 v[76:77], v39 offset:12544
  ds_read_b64_tr_b16 v[78:79], v39 offset:13056
  s_add_u32 s58, s71, 81920
  buffer_load_dwordx4 a[32:35], v41, s[12:15], s58 offen sc1
  s_mov_b32 s59, 163840
  s_add_u32 m0, s52, 16384
  s_nop 0
  buffer_load_dwordx4 v31, s[20:23], s59 offen lds
  s_waitcnt lgkmcnt(10)
  v_mfma_f32_32x32x16_bf16 v[96:111], v[56:59], a[52:55], v[96:111]
  s_barrier
  ds_read_b64_tr_b16 v[48:49], v39 offset:57344
  ds_read_b64_tr_b16 v[50:51], v39 offset:57856
  s_waitcnt lgkmcnt(10)
  v_mfma_f32_32x32x16_bf16 v[112:127], v[60:63], a[52:55], v[112:127]
  ds_read_b64_tr_b16 v[52:53], v39 offset:57600
  ds_read_b64_tr_b16 v[54:55], v39 offset:58112
  s_add_u32 s58, s71, 83968
  buffer_load_dwordx4 a[36:39], v41, s[12:15], s58 offen sc1
  s_mov_b32 s59, 196608
  s_add_u32 m0, s52, 20480
  s_nop 0
  buffer_load_dwordx4 v31, s[20:23], s59 offen lds
  s_waitcnt lgkmcnt(10)
  v_mfma_f32_32x32x16_bf16 v[96:111], v[64:67], a[56:59], v[96:111]
  ds_read_b64_tr_b16 v[56:57], v39 offset:61440
  ds_read_b64_tr_b16 v[58:59], v39 offset:61952
  s_waitcnt lgkmcnt(10)
  v_mfma_f32_32x32x16_bf16 v[112:127], v[68:71], a[56:59], v[112:127]
  ds_read_b64_tr_b16 v[60:61], v39 offset:61696
  ds_read_b64_tr_b16 v[62:63], v39 offset:62208
  s_add_u32 s58, s71, 86016
  buffer_load_dwordx4 a[40:43], v41, s[12:15], s58 offen sc1
  s_mov_b32 s59, 229376
  s_add_u32 m0, s52, 24576
  s_nop 0
  buffer_load_dwordx4 v31, s[20:23], s59 offen lds
  s_waitcnt lgkmcnt(10)
  v_mfma_f32_32x32x16_bf16 v[96:111], v[72:75], a[60:63], v[96:111]
  ds_read_b64_tr_b16 v[64:65], v39 offset:16384
  ds_read_b64_tr_b16 v[66:67], v39 offset:16896
  s_waitcnt lgkmcnt(10)
  v_mfma_f32_32x32x16_bf16 v[112:127], v[76:79], a[60:63], v[112:127]
  ds_read_b64_tr_b16 v[68:69], v39 offset:16640
  ds_read_b64_tr_b16 v[70:71], v39 offset:17152
  s_mov_b32 s59, 262144
  s_add_u32 m0, s52, 28672
  s_nop 0
  buffer_load_dwordx4 v31, s[20:23], s59 offen lds
  s_waitcnt lgkmcnt(10)
  s_waitcnt vmcnt(14)
  v_mfma_f32_32x32x16_bf16 v[96:111], v[48:51], a[0:3], v[96:111]
  ds_read_b64_tr_b16 v[72:73], v39 offset:20480
  ds_read_b64_tr_b16 v[74:75], v39 offset:20992
  s_waitcnt lgkmcnt(10)
  v_mfma_f32_32x32x16_bf16 v[112:127], v[52:55], a[0:3], v[112:127]
  ds_read_b64_tr_b16 v[76:77], v39 offset:20736
  ds_read_b64_tr_b16 v[78:79], v39 offset:21248
  s_mov_b32 s59, 294912
  s_add_u32 m0, s52, 32768
  s_nop 0
  buffer_load_dwordx4 v31, s[20:23], s59 offen lds
  s_waitcnt lgkmcnt(10)
  s_waitcnt vmcnt(14)
  v_mfma_f32_32x32x16_bf16 v[96:111], v[56:59], a[4:7], v[96:111]
  ds_read_b64_tr_b16 v[48:49], v39 offset:24576
  ds_read_b64_tr_b16 v[50:51], v39 offset:25088
  s_waitcnt lgkmcnt(10)
  v_mfma_f32_32x32x16_bf16 v[112:127], v[60:63], a[4:7], v[112:127]
  ds_read_b64_tr_b16 v[52:53], v39 offset:24832
  ds_read_b64_tr_b16 v[54:55], v39 offset:25344
  s_mov_b32 s59, 327680
  s_add_u32 m0, s52, 36864
  s_nop 0
  buffer_load_dwordx4 v31, s[20:23], s59 offen lds
  s_waitcnt lgkmcnt(10)
  s_waitcnt vmcnt(14)
  v_mfma_f32_32x32x16_bf16 v[96:111], v[64:67], a[8:11], v[96:111]
  ds_read_b64_tr_b16 v[56:57], v39 offset:28672
  ds_read_b64_tr_b16 v[58:59], v39 offset:29184
  s_waitcnt lgkmcnt(10)
  v_mfma_f32_32x32x16_bf16 v[112:127], v[68:71], a[8:11], v[112:127]
  ds_read_b64_tr_b16 v[60:61], v39 offset:28928
  ds_read_b64_tr_b16 v[62:63], v39 offset:29440
  s_mov_b32 s59, 360448
  s_add_u32 m0, s52, 40960
  s_nop 0
  buffer_load_dwordx4 v31, s[20:23], s59 offen lds
  s_waitcnt lgkmcnt(10)
  s_waitcnt vmcnt(14)
  v_mfma_f32_32x32x16_bf16 v[96:111], v[72:75], a[12:15], v[96:111]
  ds_read_b64_tr_b16 v[64:65], v39 offset:32768
  ds_read_b64_tr_b16 v[66:67], v39 offset:33280
  s_waitcnt lgkmcnt(10)
  v_mfma_f32_32x32x16_bf16 v[112:127], v[76:79], a[12:15], v[112:127]
  ds_read_b64_tr_b16 v[68:69], v39 offset:33024
  ds_read_b64_tr_b16 v[70:71], v39 offset:33536
  s_mov_b32 s59, 393216
  s_add_u32 m0, s52, 45056
  s_nop 0
  buffer_load_dwordx4 v31, s[20:23], s59 offen lds
  s_waitcnt lgkmcnt(10)
  s_waitcnt vmcnt(14)
  v_mfma_f32_32x32x16_bf16 v[96:111], v[48:51], a[16:19], v[96:111]
  ds_read_b64_tr_b16 v[72:73], v39 offset:36864
  ds_read_b64_tr_b16 v[74:75], v39 offset:37376
  s_waitcnt lgkmcnt(10)
  v_mfma_f32_32x32x16_bf16 v[112:127], v[52:55], a[16:19], v[112:127]
  ds_read_b64_tr_b16 v[76:77], v39 offset:37120
  ds_read_b64_tr_b16 v[78:79], v39 offset:37632
  s_mov_b32 s59, 425984
  s_add_u32 m0, s52, 49152
  s_nop 0
  buffer_load_dwordx4 v31, s[20:23], s59 offen lds
  s_waitcnt lgkmcnt(10)
  s_waitcnt vmcnt(14)
  v_mfma_f32_32x32x16_bf16 v[96:111], v[56:59], a[20:23], v[96:111]
  s_barrier
  ds_read_b64_tr_b16 v[48:49], v39 offset:40960
  ds_read_b64_tr_b16 v[50:51], v39 offset:41472
  s_waitcnt lgkmcnt(10)
  v_mfma_f32_32x32x16_bf16 v[112:127], v[60:63], a[20:23], v[112:127]
  ds_read_b64_tr_b16 v[52:53], v39 offset:41216
  ds_read_b64_tr_b16 v[54:55], v39 offset:41728
  s_mov_b32 s59, 458752
  s_add_u32 m0, s52, 53248
  s_nop 0
  buffer_load_dwordx4 v31, s[20:23], s59 offen lds
  s_lshl_b32 s55, s45, 7
  s_add_u32 s55, s55, 16384
  s_cmp_eq_u32 s36, 0
  s_cbranch_scc0 L_pi_49
  v_mov_b32 v12, s55
  s_mov_b64 exec, 1
  buffer_load_dword v13, v12, s[12:15], 0 offen sc1
  s_mov_b64 exec, -1
L_pi_49:
  s_waitcnt lgkmcnt(10)
  s_waitcnt vmcnt(14)
  v_mfma_f32_32x32x16_bf16 v[96:111], v[64:67], a[24:27], v[96:111]
  ds_read_b64_tr_b16 v[56:57], v39 offset:45056
  ds_read_b64_tr_b16 v[58:59], v39 offset:45568
  s_waitcnt lgkmcnt(10)
  v_mfma_f32_32x32x16_bf16 v[112:127], v[68:71], a[24:27], v[112:127]
  ds_read_b64_tr_b16 v[60:61], v39 offset:45312
  ds_read_b64_tr_b16 v[62:63], v39 offset:45824
  s_mov_b32 s59, 491520
  s_add_u32 m0, s52, 57344
  s_nop 0
  buffer_load_dwordx4 v31, s[20:23], s59 offen lds
  s_waitcnt lgkmcnt(10)
  s_waitcnt vmcnt(14)
  v_mfma_f32_32x32x16_bf16 v[96:111], v[72:75], a[28:31], v[96:111]
  ds_read_b64_tr_b16 v[64:65], v39 offset:49152
  ds_read_b64_tr_b16 v[66:67], v39 offset:49664
  s_waitcnt lgkmcnt(10)
  v_mfma_f32_32x32x16_bf16 v[112:127], v[76:79], a[28:31], v[112:127]
  ds_read_b64_tr_b16 v[68:69], v39 offset:49408
  ds_read_b64_tr_b16 v[70:71], v39 offset:49920
  s_waitcnt lgkmcnt(10)
  s_waitcnt vmcnt(13)
  v_mfma_f32_32x32x16_bf16 v[96:111], v[48:51], a[32:35], v[96:111]
  ds_read_b64_tr_b16 v[72:73], v39 offset:53248
  ds_read_b64_tr_b16 v[74:75], v39 offset:53760
  s_waitcnt lgkmcnt(10)
  v_mfma_f32_32x32x16_bf16 v[112:127], v[52:55], a[32:35], v[112:127]
  ds_read_b64_tr_b16 v[76:77], v39 offset:53504
  ds_read_b64_tr_b16 v[78:79], v39 offset:54016
  s_waitcnt lgkmcnt(10)
  s_waitcnt vmcnt(11)
  v_mfma_f32_32x32x16_bf16 v[96:111], v[56:59], a[36:39], v[96:111]
  ds_read_b64_tr_b16 v[48:49], v38 offset:0
  ds_read_b64_tr_b16 v[50:51], v38 offset:512
  s_waitcnt lgkmcnt(10)
  v_mfma_f32_32x32x16_bf16 v[112:127], v[60:63], a[36:39], v[112:127]
  ds_read_b64_tr_b16 v[52:53], v38 offset:256
  ds_read_b64_tr_b16 v[54:55], v38 offset:768
  s_waitcnt lgkmcnt(10)
  s_waitcnt vmcnt(9)
  v_mfma_f32_32x32x16_bf16 v[96:111], v[64:67], a[40:43], v[96:111]
  ds_read_b64_tr_b16 v[56:57], v38 offset:4096
  ds_read_b64_tr_b16 v[58:59], v38 offset:4608
  s_waitcnt lgkmcnt(10)
  v_mfma_f32_32x32x16_bf16 v[112:127], v[68:71], a[40:43], v[112:127]
  ds_read_b64_tr_b16 v[60:61], v38 offset:4352
  ds_read_b64_tr_b16 v[62:63], v38 offset:4864
  s_cmp_eq_u32 s36, 0
  s_cbranch_scc0 L_pc_50
  s_waitcnt vmcnt(1)
  s_mov_b64 exec, 1
  v_cmp_ne_u32 vcc, 8, v13
  s_cbranch_vccz L_cod_52
  s_mov_b32 s60, 0
L_co_51:
  buffer_load_dword v13, v12, s[12:15], 0 offen sc1
  s_add_u32 s60, s60, 1
  s_waitcnt vmcnt(0)
  v_cmp_ne_u32 vcc, 8, v13
  s_cmp_gt_u32 s60, 0x20000
  s_cbranch_scc1 L_cod_52
  s_cbranch_vccnz L_co_51
L_cod_52:
  s_mov_b64 exec, -1
L_pc_50:
  s_barrier
  s_nop 0
  s_add_u32 s58, s71, 88064
  buffer_load_dwordx4 a[44:47], v41, s[12:15], s58 offen sc1
  s_add_u32 s58, s71, 90112
  buffer_load_dwordx4 a[48:51], v41, s[12:15], s58 offen sc1
  s_add_u32 s58, s71, 92160
  buffer_load_dwordx4 a[52:55], v41, s[12:15], s58 offen sc1
  s_add_u32 s58, s71, 94208
  buffer_load_dwordx4 a[56:59], v41, s[12:15], s58 offen sc1
  s_lshl_b32 s53, s36, 12
  s_add_u32 s53, s53, 131072
  v_add_u32 v2, s53, v41
  s_xor_b32 s54, s36, 1
  s_lshl_b32 s54, s54, 12
  s_add_u32 s54, s54, 131072
  v_add_u32_e64 v3, s54, v41
  s_cmp_eq_u32 s42, 0
  s_cbranch_scc0 L_rdB_53
  ds_write_b128 v2, v[112:115] offset:0
  ds_write_b128 v2, v[116:119] offset:1024
  ds_write_b128 v2, v[120:123] offset:2048
  ds_write_b128 v2, v[124:127] offset:3072
  s_waitcnt lgkmcnt(0)
  s_barrier
  ds_read_b128 v[192:195], v3 offset:0
  ds_read_b128 v[196:199], v3 offset:1024
  ds_read_b128 v[200:203], v3 offset:2048
  ds_read_b128 v[204:207], v3 offset:3072
  s_waitcnt lgkmcnt(0)
  s_nop 0
  v_pk_add_f32 v[80:81], v[96:97], v[192:193]
  v_pk_add_f32 v[82:83], v[98:99], v[194:195]
  v_pk_add_f32 v[84:85], v[100:101], v[196:197]
  v_pk_add_f32 v[86:87], v[102:103], v[198:199]
  v_pk_add_f32 v[88:89], v[104:105], v[200:201]
  v_pk_add_f32 v[90:91], v[106:107], v[202:203]
  v_pk_add_f32 v[92:93], v[108:109], v[204:205]
  v_pk_add_f32 v[94:95], v[110:111], v[206:207]
  s_branch L_rdE_54
L_rdB_53:
  ds_write_b128 v2, v[96:99] offset:0
  ds_write_b128 v2, v[100:103] offset:1024
  ds_write_b128 v2, v[104:107] offset:2048
  ds_write_b128 v2, v[108:111] offset:3072
  s_waitcnt lgkmcnt(0)
  s_barrier
  ds_read_b128 v[192:195], v3 offset:0
  ds_read_b128 v[196:199], v3 offset:1024
  ds_read_b128 v[200:203], v3 offset:2048
  ds_read_b128 v[204:207], v3 offset:3072
  s_waitcnt lgkmcnt(0)
  v_pk_add_f32 v[80:81], v[112:113], v[192:193]
  v_pk_add_f32 v[82:83], v[114:115], v[194:195]
  v_pk_add_f32 v[84:85], v[116:117], v[196:197]
  v_pk_add_f32 v[86:87], v[118:119], v[198:199]
  v_pk_add_f32 v[88:89], v[120:121], v[200:201]
  v_pk_add_f32 v[90:91], v[122:123], v[202:203]
  v_pk_add_f32 v[92:93], v[124:125], v[204:205]
  v_pk_add_f32 v[94:95], v[126:127], v[206:207]
L_rdE_54:
  s_add_u32 s58, s71, 96256
  buffer_load_dwordx4 a[60:63], v41, s[12:15], s58 offen sc1
  s_add_u32 s58, s71, 98304
  buffer_load_dwordx4 a[0:3], v41, s[12:15], s58 offen sc1
  s_mov_b32 s100, 0xbfb8aa3b
  s_mov_b32 s101, 0xbfb8aa3b
  v_pk_mul_f32 v[208:209], v[80:81], s[100:101]
  v_pk_mul_f32 v[210:211], v[82:83], s[100:101]
  v_pk_mul_f32 v[212:213], v[84:85], s[100:101]
  v_pk_mul_f32 v[214:215], v[86:87], s[100:101]
  v_pk_mul_f32 v[216:217], v[88:89], s[100:101]
  v_pk_mul_f32 v[218:219], v[90:91], s[100:101]
  v_pk_mul_f32 v[220:221], v[92:93], s[100:101]
  v_pk_mul_f32 v[222:223], v[94:95], s[100:101]
  s_add_u32 s58, s71, 100352
  buffer_load_dwordx4 a[4:7], v41, s[12:15], s58 offen sc1
  v_exp_f32 v208, v208
  v_exp_f32 v209, v209
  v_exp_f32 v210, v210
  v_exp_f32 v211, v211
  v_exp_f32 v212, v212
  v_exp_f32 v213, v213
  v_exp_f32 v214, v214
  v_exp_f32 v215, v215
  s_add_u32 s58, s71, 102400
  buffer_load_dwordx4 a[8:11], v41, s[12:15], s58 offen sc1
  v_exp_f32 v216, v216
  v_exp_f32 v217, v217
  v_exp_f32 v218, v218
  v_exp_f32 v219, v219
  v_exp_f32 v220, v220
  v_exp_f32 v221, v221
  v_exp_f32 v222, v222
  v_exp_f32 v223, v223
  s_add_u32 s58, s71, 104448
  buffer_load_dwordx4 a[12:15], v41, s[12:15], s58 offen sc1
  v_pk_add_f32 v[208:209], v[208:209], 1.0 op_sel_hi:[1,0]
  v_pk_add_f32 v[210:211], v[210:211], 1.0 op_sel_hi:[1,0]
  v_pk_add_f32 v[212:213], v[212:213], 1.0 op_sel_hi:[1,0]
  v_pk_add_f32 v[214:215], v[214:215], 1.0 op_sel_hi:[1,0]
  v_pk_add_f32 v[216:217], v[216:217], 1.0 op_sel_hi:[1,0]
  v_pk_add_f32 v[218:219], v[218:219], 1.0 op_sel_hi:[1,0]
  v_pk_add_f32 v[220:221], v[220:221], 1.0 op_sel_hi:[1,0]
  v_pk_add_f32 v[222:223], v[222:223], 1.0 op_sel_hi:[1,0]
  s_add_u32 s58, s71, 106496
  buffer_load_dwordx4 a[16:19], v41, s[12:15], s58 offen sc1
  v_rcp_f32 v208, v208
  v_rcp_f32 v209, v209
  v_rcp_f32 v210, v210
  v_rcp_f32 v211, v211
  v_rcp_f32 v212, v212
  v_rcp_f32 v213, v213
  v_rcp_f32 v214, v214
  v_rcp_f32 v215, v215
  s_add_u32 s58, s71, 108544
  buffer_load_dwordx4 a[20:23], v41, s[12:15], s58 offen sc1
  v_rcp_f32 v216, v216
  v_rcp_f32 v217, v217
  v_rcp_f32 v218, v218
  v_rcp_f32 v219, v219
  v_rcp_f32 v220, v220
  v_rcp_f32 v221, v221
  v_rcp_f32 v222, v222
  v_rcp_f32 v223, v223
  s_add_u32 s58, s71, 110592
  buffer_load_dwordx4 a[24:27], v41, s[12:15], s58 offen sc1
  v_lshlrev_b32_e64 v224, 16, v160
  v_and_b32 v225, 0xffff0000, v160
  v_lshlrev_b32_e64 v226, 16, v161
  v_and_b32 v227, 0xffff0000, v161
  v_lshlrev_b32_e64 v228, 16, v162
  v_and_b32 v229, 0xffff0000, v162
  v_lshlrev_b32_e64 v230, 16, v163
  v_and_b32 v231, 0xffff0000, v163
  s_add_u32 s58, s71, 112640
  buffer_load_dwordx4 a[28:31], v41, s[12:15], s58 offen sc1
  v_lshlrev_b32_e64 v232, 16, v164
  v_and_b32 v233, 0xffff0000, v164
  v_lshlrev_b32_e64 v234, 16, v165
  v_and_b32 v235, 0xffff0000, v165
  v_lshlrev_b32_e64 v236, 16, v166
  v_and_b32 v237, 0xffff0000, v166
  v_lshlrev_b32_e64 v238, 16, v167
  v_and_b32 v239, 0xffff0000, v167
  s_add_u32 s58, s71, 114688
  buffer_load_dwordx4 a[32:35], v41, s[12:15], s58 offen sc1
  v_pk_mul_f32 v[80:81], v[80:81], v[208:209]
  v_pk_mul_f32 v[82:83], v[82:83], v[210:211]
  v_pk_mul_f32 v[84:85], v[84:85], v[212:213]
  v_pk_mul_f32 v[86:87], v[86:87], v[214:215]
  v_pk_mul_f32 v[88:89], v[88:89], v[216:217]
  v_pk_mul_f32 v[90:91], v[90:91], v[218:219]
  v_pk_mul_f32 v[92:93], v[92:93], v[220:221]
  v_pk_mul_f32 v[94:95], v[94:95], v[222:223]
  s_add_u32 s58, s71, 116736
  buffer_load_dwordx4 a[36:39], v41, s[12:15], s58 offen sc1
  s_add_u32 s58, s71, 118784
  buffer_load_dwordx4 a[40:43], v41, s[12:15], s58 offen sc1
  s_waitcnt vmcnt(15)
  v_mfma_f32_32x32x16_bf16 v[128:143], v[72:75], a[44:47], 0
  ds_read_b64_tr_b16 v[64:65], v38 offset:8192
  ds_read_b64_tr_b16 v[66:67], v38 offset:8704
  v_mfma_f32_32x32x16_bf16 v[144:159], v[76:79], a[44:47], 0
  ds_read_b64_tr_b16 v[68:69], v38 offset:8448
  ds_read_b64_tr_b16 v[70:71], v38 offset:8960
  s_waitcnt vmcnt(14)
  v_mfma_f32_32x32x16_bf16 v[128:143], v[48:51], a[48:51], v[128:143]
  ds_read_b64_tr_b16 v[72:73], v38 offset:12288
  ds_read_b64_tr_b16 v[74:75], v38 offset:12800
  v_mfma_f32_32x32x16_bf16 v[144:159], v[52:55], a[48:51], v[144:159]
  ds_read_b64_tr_b16 v[76:77], v38 offset:12544
  ds_read_b64_tr_b16 v[78:79], v38 offset:13056
  s_waitcnt vmcnt(13)
  v_mfma_f32_32x32x16_bf16 v[128:143], v[56:59], a[52:55], v[128:143]
  s_barrier
  ds_read_b64_tr_b16 v[48:49], v38 offset:16384
  ds_read_b64_tr_b16 v[50:51], v38 offset:16896
  v_mfma_f32_32x32x16_bf16 v[144:159], v[60:63], a[52:55], v[144:159]
  ds_read_b64_tr_b16 v[52:53], v38 offset:16640
  ds_read_b64_tr_b16 v[54:55], v38 offset:17152
  s_waitcnt lgkmcnt(10)
  s_waitcnt vmcnt(12)
  v_mfma_f32_32x32x16_bf16 v[128:143], v[64:67], a[56:59], v[128:143]
  ds_read_b64_tr_b16 v[56:57], v38 offset:20480
  ds_read_b64_tr_b16 v[58:59], v38 offset:20992
  s_waitcnt lgkmcnt(10)
  v_mfma_f32_32x32x16_bf16 v[144:159], v[68:71], a[56:59], v[144:159]
  ds_read_b64_tr_b16 v[60:61], v38 offset:20736
  ds_read_b64_tr_b16 v[62:63], v38 offset:21248
  s_waitcnt lgkmcnt(10)
  s_waitcnt vmcnt(11)
  v_mfma_f32_32x32x16_bf16 v[128:143], v[72:75], a[60:63], v[128:143]
  ds_read_b64_tr_b16 v[64:65], v38 offset:24576
  ds_read_b64_tr_b16 v[66:67], v38 offset:25088
  s_waitcnt lgkmcnt(10)
  v_mfma_f32_32x32x16_bf16 v[144:159], v[76:79], a[60:63], v[144:159]
  ds_read_b64_tr_b16 v[68:69], v38 offset:24832
  ds_read_b64_tr_b16 v[70:71], v38 offset:25344
  s_waitcnt lgkmcnt(10)
  s_waitcnt vmcnt(10)
  v_mfma_f32_32x32x16_bf16 v[128:143], v[48:51], a[0:3], v[128:143]
  ds_read_b64_tr_b16 v[72:73], v38 offset:28672
  ds_read_b64_tr_b16 v[74:75], v38 offset:29184
  s_waitcnt lgkmcnt(10)
  v_mfma_f32_32x32x16_bf16 v[144:159], v[52:55], a[0:3], v[144:159]
  ds_read_b64_tr_b16 v[76:77], v38 offset:28928
  ds_read_b64_tr_b16 v[78:79], v38 offset:29440
  s_waitcnt lgkmcnt(10)
  s_waitcnt vmcnt(9)
  v_mfma_f32_32x32x16_bf16 v[128:143], v[56:59], a[4:7], v[128:143]
  ds_read_b64_tr_b16 v[48:49], v38 offset:32768
  ds_read_b64_tr_b16 v[50:51], v38 offset:33280
  s_waitcnt lgkmcnt(10)
  v_mfma_f32_32x32x16_bf16 v[144:159], v[60:63], a[4:7], v[144:159]
  ds_read_b64_tr_b16 v[52:53], v38 offset:33024
  ds_read_b64_tr_b16 v[54:55], v38 offset:33536
  s_waitcnt lgkmcnt(10)
  s_waitcnt vmcnt(8)
  v_mfma_f32_32x32x16_bf16 v[128:143], v[64:67], a[8:11], v[128:143]
  ds_read_b64_tr_b16 v[56:57], v38 offset:36864
  ds_read_b64_tr_b16 v[58:59], v38 offset:37376
  s_waitcnt lgkmcnt(10)
  v_mfma_f32_32x32x16_bf16 v[144:159], v[68:71], a[8:11], v[144:159]
  ds_read_b64_tr_b16 v[60:61], v38 offset:37120
  ds_read_b64_tr_b16 v[62:63], v38 offset:37632
  s_waitcnt lgkmcnt(10)
  s_waitcnt vmcnt(7)
  v_mfma_f32_32x32x16_bf16 v[128:143], v[72:75], a[12:15], v[128:143]
  ds_read_b64_tr_b16 v[64:65], v38 offset:40960
  ds_read_b64_tr_b16 v[66:67], v38 offset:41472
  s_waitcnt lgkmcnt(10)
  v_mfma_f32_32x32x16_bf16 v[144:159], v[76:79], a[12:15], v[144:159]
  ds_read_b64_tr_b16 v[68:69], v38 offset:41216
  ds_read_b64_tr_b16 v[70:71], v38 offset:41728
  s_waitcnt lgkmcnt(10)
  s_waitcnt vmcnt(6)
  v_mfma_f32_32x32x16_bf16 v[128:143], v[48:51], a[16:19], v[128:143]
  ds_read_b64_tr_b16 v[72:73], v38 offset:45056
  ds_read_b64_tr_b16 v[74:75], v38 offset:45568
  s_waitcnt lgkmcnt(10)
  v_mfma_f32_32x32x16_bf16 v[144:159], v[52:55], a[16:19], v[144:159]
  ds_read_b64_tr_b16 v[76:77], v38 offset:45312
  ds_read_b64_tr_b16 v[78:79], v38 offset:45824
  s_waitcnt lgkmcnt(10)
  s_waitcnt vmcnt(5)
  v_mfma_f32_32x32x16_bf16 v[128:143], v[56:59], a[20:23], v[128:143]
  ds_read_b64_tr_b16 v[48:49], v38 offset:49152
  ds_read_b64_tr_b16 v[50:51], v38 offset:49664
  s_waitcnt lgkmcnt(10)
  v_mfma_f32_32x32x16_bf16 v[144:159], v[60:63], a[20:23], v[144:159]
  ds_read_b64_tr_b16 v[52:53], v38 offset:49408
  ds_read_b64_tr_b16 v[54:55], v38 offset:49920
  s_waitcnt lgkmcnt(10)
  s_waitcnt vmcnt(4)
  v_mfma_f32_32x32x16_bf16 v[128:143], v[64:67], a[24:27], v[128:143]
  ds_read_b64_tr_b16 v[56:57], v38 offset:53248
  ds_read_b64_tr_b16 v[58:59], v38 offset:53760
  s_waitcnt lgkmcnt(10)
  v_mfma_f32_32x32x16_bf16 v[144:159], v[68:71], a[24:27], v[144:159]
  ds_read_b64_tr_b16 v[60:61], v38 offset:53504
  ds_read_b64_tr_b16 v[62:63], v38 offset:54016
  s_waitcnt lgkmcnt(10)
  s_waitcnt vmcnt(3)
  v_mfma_f32_32x32x16_bf16 v[128:143], v[72:75], a[28:31], v[128:143]
  ds_read_b64_tr_b16 v[64:65], v38 offset:57344
  ds_read_b64_tr_b16 v[66:67], v38 offset:57856
  s_waitcnt lgkmcnt(10)
  v_mfma_f32_32x32x16_bf16 v[144:159], v[76:79], a[28:31], v[144:159]
  ds_read_b64_tr_b16 v[68:69], v38 offset:57600
  ds_read_b64_tr_b16 v[70:71], v38 offset:58112
  s_waitcnt lgkmcnt(10)
  s_waitcnt vmcnt(2)
  v_mfma_f32_32x32x16_bf16 v[128:143], v[48:51], a[32:35], v[128:143]
  s_waitcnt lgkmcnt(8)
  v_mfma_f32_32x32x16_bf16 v[144:159], v[52:55], a[32:35], v[144:159]
  s_waitcnt lgkmcnt(6)
  s_waitcnt vmcnt(1)
  v_mfma_f32_32x32x16_bf16 v[128:143], v[56:59], a[36:39], v[128:143]
  s_waitcnt lgkmcnt(4)
  v_mfma_f32_32x32x16_bf16 v[144:159], v[60:63], a[36:39], v[144:159]
  s_waitcnt lgkmcnt(2)
  s_waitcnt vmcnt(0)
  v_mfma_f32_32x32x16_bf16 v[128:143], v[64:67], a[40:43], v[128:143]
  s_waitcnt lgkmcnt(0)
  v_mfma_f32_32x32x16_bf16 v[144:159], v[68:71], a[40:43], v[144:159]
  s_lshl_b32 s53, s36, 12
  s_add_u32 s53, s53, 131072
  v_add_u32_e64 v2, s53, v41
  s_xor_b32 s54, s36, 1
  s_lshl_b32 s54, s54, 12
  s_add_u32 s54, s54, 131072
  v_add_u32 v3, s54, v41
  s_cmp_eq_u32 s42, 0
  s_cbranch_scc0 L_rdB_55
  s_nop 2
  ds_write_b128 v2, v[144:147] offset:0
  ds_write_b128 v2, v[148:151] offset:1024
  ds_write_b128 v2, v[152:155] offset:2048
  ds_write_b128 v2, v[156:159] offset:3072
  s_waitcnt lgkmcnt(0)
  s_barrier
  ds_read_b128 v[192:195], v3 offset:0
  ds_read_b128 v[196:199], v3 offset:1024
  ds_read_b128 v[200:203], v3 offset:2048
  ds_read_b128 v[204:207], v3 offset:3072
  s_waitcnt lgkmcnt(0)
  s_nop 0
  v_pk_add_f32 v[176:177], v[128:129], v[192:193]
  v_pk_add_f32 v[178:179], v[130:131], v[194:195]
  v_pk_add_f32 v[180:181], v[132:133], v[196:197]
  v_pk_add_f32 v[182:183], v[134:135], v[198:199]
  v_pk_add_f32 v[184:185], v[136:137], v[200:201]
  v_pk_add_f32 v[186:187], v[138:139], v[202:203]
  v_pk_add_f32 v[188:189], v[140:141], v[204:205]
  v_pk_add_f32 v[190:191], v[142:143], v[206:207]
  s_branch L_rdE_56
L_rdB_55:
  s_nop 0
  ds_write_b128 v2, v[128:131] offset:0
  ds_write_b128 v2, v[132:135] offset:1024
  ds_write_b128 v2, v[136:139] offset:2048
  ds_write_b128 v2, v[140:143] offset:3072
  s_waitcnt lgkmcnt(0)
  s_barrier
  ds_read_b128 v[192:195], v3 offset:0
  ds_read_b128 v[196:199], v3 offset:1024
  ds_read_b128 v[200:203], v3 offset:2048
  ds_read_b128 v[204:207], v3 offset:3072
  s_waitcnt lgkmcnt(0)
  s_nop 0
  v_pk_add_f32 v[176:177], v[144:145], v[192:193]
  v_pk_add_f32 v[178:179], v[146:147], v[194:195]
  v_pk_add_f32 v[180:181], v[148:149], v[196:197]
  v_pk_add_f32 v[182:183], v[150:151], v[198:199]
  v_pk_add_f32 v[184:185], v[152:153], v[200:201]
  v_pk_add_f32 v[186:187], v[154:155], v[202:203]
  v_pk_add_f32 v[188:189], v[156:157], v[204:205]
  v_pk_add_f32 v[190:191], v[158:159], v[206:207]
L_rdE_56:
  v_pk_fma_f32 v[176:177], v[80:81], v[176:177], v[224:225]
  v_pk_fma_f32 v[178:179], v[82:83], v[178:179], v[226:227]
  v_pk_fma_f32 v[180:181], v[84:85], v[180:181], v[228:229]
  v_pk_fma_f32 v[182:183], v[86:87], v[182:183], v[230:231]
  v_pk_fma_f32 v[184:185], v[88:89], v[184:185], v[232:233]
  v_pk_fma_f32 v[186:187], v[90:91], v[186:187], v[234:235]
  v_pk_fma_f32 v[188:189], v[92:93], v[188:189], v[236:237]
  v_pk_fma_f32 v[190:191], v[94:95], v[190:191], v[238:239]
  v_cvt_pk_bf16_f32 v176, v176, v177
  v_cvt_pk_bf16_f32 v177, v178, v179
  v_cvt_pk_bf16_f32 v178, v180, v181
  v_cvt_pk_bf16_f32 v179, v182, v183
  v_cvt_pk_bf16_f32 v180, v184, v185
  v_cvt_pk_bf16_f32 v181, v186, v187
  v_cvt_pk_bf16_f32 v182, v188, v189
  v_cvt_pk_bf16_f32 v183, v190, v191
  buffer_store_dwordx4 v[176:179], v168, s[24:27], 0 offen
  buffer_store_dwordx4 v[180:183], v168, s[24:27], 0 offen offset:16
  s_waitcnt vmcnt(0) lgkmcnt(0)
L_end:
  s_endpgm
L_codeend:
.section .rodata,"a"
.p2align 6
.amdhsa_kernel recurrent_scan__linear_kernel_hedgehog__dense_activation_silu__prompt_kernel
  .amdhsa_next_free_vgpr 496
  .amdhsa_next_free_sgpr 102
  .amdhsa_accum_offset 256
  .amdhsa_group_segment_fixed_size 0
  .amdhsa_kernarg_size 80
  .amdhsa_user_sgpr_count 2
  .amdhsa_user_sgpr_kernarg_segment_ptr 1
  .amdhsa_system_sgpr_workgroup_id_x 1
.end_amdhsa_kernel
```
